```python
import torch

def _softmax(x, axis=-1):
    return torch.softmax(x, dim=axis)

def _gelu(x):
    return torch.nn.functional.gelu(x, approximate='tanh')

def _silu(x):
    return torch.nn.functional.silu(x)

def _sigmoid(x):
    return torch.sigmoid(x)

def _layernorm(x, axis=-1, eps=1e-05):
    m = x.mean(dim=axis, keepdim=True)
    v = x.var(dim=axis, keepdim=True, unbiased=False)
    return (x - m) / torch.sqrt(v + eps)

def _scatter_add(tgt, idx, src, axis=0):
    return tgt.clone().index_add_(axis, idx, src)

def _segment_sum(src, seg, n):
    out = torch.zeros((n,) + src.shape[1:], dtype=src.dtype)
    return out.index_add_(0, seg, src)

def _pad(x, pw):
    flat = tuple((v for pair in reversed(pw) for v in pair))
    return torch.nn.functional.pad(x, flat)
kernel_name = 'sequential_preLN__memory_aug_recurrent_mem_tr__geglu_ffn__prompt'

def setup_inputs():

    _w = lambda a: (lambda t: t.to(torch.bfloat16) if t.is_floating_point() else t)(torch.as_tensor(a))

    def _A_setup():
        B, S, Dm = (1, 2048, 512)
        H, Dh = (32, 128)
        M, seg = (8, 32)
        seg = min(seg, S)
        S = S // seg * seg
        return {'x': _w((lambda *s: torch.randn(*s, dtype=torch.bfloat16) * 0.05)(B, S, Dm)), 'mem0': _w((lambda *s: torch.randn(*s, dtype=torch.bfloat16) * 0.2)(B, M, Dm)), 'Wq': _w((lambda *s: torch.randn(*s, dtype=torch.bfloat16) * 1.6)(Dm, H, Dh) * Dm ** (-0.5)), 'Wk': _w((lambda *s: torch.randn(*s, dtype=torch.bfloat16) * 1.6)(Dm, H, Dh) * Dm ** (-0.5)), 'Wv': _w((lambda *s: torch.randn(*s, dtype=torch.bfloat16) * 0.2)(Dm, H, Dh) * Dm ** (-0.5)), 'Wo': _w((lambda *s: torch.randn(*s, dtype=torch.bfloat16) * 0.2)(H, Dh, Dm) * (H * Dh) ** (-0.5)), 'seg_len': seg}
    _A_in = _A_setup()

    def _B_setup():
        B, S, D, F = (1, 2048, 512, 1792)
        return {'x': _w((lambda *s: torch.randn(*s, dtype=torch.bfloat16) * 0.05)(B, S, D)), 'w_gate': _w((lambda *s: torch.randn(*s, dtype=torch.bfloat16) * 0.05)(D, F)), 'w_up': _w((lambda *s: torch.randn(*s, dtype=torch.bfloat16) * 0.05)(D, F)), 'w_down': _w((lambda *s: torch.randn(*s, dtype=torch.bfloat16) * 0.05)(F, D))}
    _B_in = _B_setup()
    return {'A_x': _A_in['x'], 'A_mem0': _A_in['mem0'], 'A_Wq': _A_in['Wq'], 'A_Wk': _A_in['Wk'], 'A_Wv': _A_in['Wv'], 'A_Wo': _A_in['Wo'], 'A_seg_len': _A_in['seg_len'], 'B_x': _B_in['x'], 'B_w_gate': _B_in['w_gate'], 'B_w_up': _B_in['w_up'], 'B_w_down': _B_in['w_down']}

def reference(A_x, A_mem0, A_Wq, A_Wk, A_Wv, A_Wo, A_seg_len, B_x, B_w_gate, B_w_up, B_w_down):

    def _A_ref(x, mem0, Wq, Wk, Wv, Wo, seg_len):
        B, S, Dm = x.shape
        H, Dh = (Wq.shape[1], Wq.shape[2])
        M = mem0.shape[1]
        scale = Dh ** (-0.5)
        n_seg = S // seg_len
        L = M + seg_len
        idx = torch.arange(L)
        mask = (idx[:, None] < M) | (idx[:, None] >= idx[None, :])
        mem = mem0
        outs = []
        for s in range(n_seg):
            xs = x[:, s * seg_len:(s + 1) * seg_len, :].clone()
            h = torch.concatenate([mem, xs], axis=1)
            q = torch.einsum('btd,dhe->bhte', h, Wq)
            k = torch.einsum('btd,dhe->bhte', h, Wk)
            v = torch.einsum('btd,dhe->bhte', h, Wv)
            scores = torch.einsum('bhqe,bhke->bhqk', q, k) * scale
            scores = torch.where(mask[None, None], scores, -1000000000.0)
            p = _softmax(scores, axis=-1)
            o = torch.einsum('bhqk,bhke->bhqe', p, v)
            o = torch.einsum('bhte,hed->btd', o, Wo)
            mem = o[:, :M, :].clone()
            outs.append(o[:, M:, :])
        return torch.concatenate(outs, axis=1)

    def _B_ref(x, w_gate, w_up, w_down):
        return _gelu(x @ w_gate) * (x @ w_up) @ w_down
    x = A_x
    h = x + _A_ref(_layernorm(x, axis=-1), A_mem0, A_Wq, A_Wk, A_Wv, A_Wo, A_seg_len)
    h2 = h + _B_ref(_layernorm(h, axis=-1), B_w_gate, B_w_up, B_w_down)
    return h2
```

```asm
; @launch kernel=prep_kernel grid=(1954,1,1) block=(256,1,1) lds=0
; @launch kernel=rec_kernel grid=(256,1,1) block=(256,1,1) lds=162176
; @launch kernel=attn_kernel grid=(512,1,1) block=(256,1,1) lds=0
; @launch kernel=wo_kernel grid=(256,1,1) block=(256,1,1) lds=0
; @launch kernel=ln2_kernel grid=(512,1,1) block=(256,1,1) lds=0
; @launch kernel=gu_kernel grid=(448,1,1) block=(256,1,1) lds=0
; @launch kernel=dn_kernel grid=(256,1,1) block=(256,1,1) lds=0
.amdgcn_target "amdgcn-amd-amdhsa--gfx950"
.text
.globl prep_kernel
.p2align 8
.type prep_kernel,@function
prep_kernel:
    s_load_dwordx4 s[20:23], s[0:1], 0
    s_load_dwordx8 s[24:31], s[0:1], 16
    s_load_dwordx4 s[32:35], s[0:1], 64
    s_load_dwordx2 s[36:37], s[0:1], 80
    s_load_dwordx2 s[38:39], s[0:1], 104
    v_and_b32 v1, 63, v0
    v_lshrrev_b32 v2, 4, v1
    v_and_b32 v3, 15, v1
    v_lshrrev_b32 v4, 6, v0
    s_nop 0
    v_readfirstlane_b32 s3, v4
    s_waitcnt lgkmcnt(0)
    s_mov_b32 s12, s38
    s_mov_b32 s13, s39
    s_mov_b32 s14, 0x10000000
    s_mov_b32 s15, 0x20000
    s_cmp_lt_u32 s2, 512
    s_cbranch_scc1 P_ln
    s_cmp_lt_u32 s2, 1280
    s_cbranch_scc1 P_pq
    s_cmp_lt_u32 s2, 1536
    s_cbranch_scc1 P_po
    s_cmp_lt_u32 s2, 1760
    s_cbranch_scc1 P_pg
    s_cmp_lt_u32 s2, 1888
    s_cbranch_scc1 P_pd
    s_cmp_lt_u32 s2, 1954
    s_cbranch_scc1 P_zero
    s_endpgm
P_pq:
    s_sub_u32 s4, s2, 512
    s_lshr_b32 s5, s4, 8
    s_and_b32 s6, s4, 255
    s_cmp_eq_u32 s5, 0
    s_cselect_b32 s8, s24, s26
    s_cselect_b32 s9, s25, s27
    s_cmp_eq_u32 s5, 2
    s_cselect_b32 s8, s28, s8
    s_cselect_b32 s9, s29, s9
    s_mov_b32 s10, 0x400000
    s_mov_b32 s11, 0x20000
    s_mov_b32 s40, 8192
    s_mov_b32 s41, 8
    s_lshl_b32 s42, s6, 5
    s_mov_b32 s43, 0
    s_mov_b32 s44, 16
    s_lshl_b32 s45, s4, 14
    s_add_u32 s45, s45, 0x200000
    s_mov_b32 s7, 0
    s_branch P_pack
P_po:
    s_sub_u32 s4, s2, 1280
    s_lshr_b32 s5, s4, 3
    s_and_b32 s6, s4, 7
    s_mov_b32 s8, s30
    s_mov_b32 s9, s31
    s_mov_b32 s10, 0x400000
    s_mov_b32 s11, 0x20000
    s_mov_b32 s40, 1024
    s_mov_b32 s41, 4
    s_lshl_b32 s42, s5, 5
    s_lshl_b32 s43, s6, 4
    s_mov_b32 s44, 16
    s_lshl_b32 s45, s5, 17
    s_lshl_b32 s46, s6, 14
    s_add_u32 s45, s45, s46
    s_add_u32 s45, s45, 0xe00000
    s_mov_b32 s7, 1
    s_branch P_pack
P_pg:
    s_sub_u32 s4, s2, 1536
    s_lshr_b32 s5, s4, 2
    s_and_b32 s6, s4, 3
    s_cmp_lt_u32 s6, 2
    s_cselect_b32 s8, s32, s34
    s_cselect_b32 s9, s33, s35
    s_mov_b32 s10, 0x1c0000
    s_mov_b32 s11, 0x20000
    s_mov_b32 s40, 3584
    s_mov_b32 s41, 8
    s_lshl_b32 s42, s5, 6
    s_and_b32 s46, s6, 1
    s_lshl_b32 s46, s46, 5
    s_add_u32 s42, s42, s46
    s_mov_b32 s43, 0
    s_mov_b32 s44, 16
    s_lshl_b32 s45, s4, 14
    s_add_u32 s45, s45, 0x1200000
    s_mov_b32 s7, 0
    s_branch P_pack
P_pd:
    s_sub_u32 s4, s2, 1760
    s_lshr_b32 s5, s4, 2
    s_and_b32 s6, s4, 3
    s_mov_b32 s8, s36
    s_mov_b32 s9, s37
    s_mov_b32 s10, 0x1c0000
    s_mov_b32 s11, 0x20000
    s_mov_b32 s40, 1024
    s_mov_b32 s41, 4
    s_lshl_b32 s42, s5, 5
    s_mul_i32 s43, s6, 14
    s_mov_b32 s44, 14
    s_mul_i32 s45, s5, 56
    s_add_u32 s45, s45, s43
    s_lshl_b32 s45, s45, 10
    s_add_u32 s45, s45, 0x1580000
    s_mov_b32 s7, 1
    s_branch P_pack
P_pack:
    s_mul_i32 s48, s40, 0
    s_mul_i32 s49, s40, 1
    s_mul_i32 s50, s40, 2
    s_mul_i32 s51, s40, 3
    s_cmp_eq_u32 s7, 1
    s_cselect_b32 s46, 16, 4
    s_mul_i32 s52, s40, s46
    s_cmp_eq_u32 s7, 1
    s_cselect_b32 s46, 17, 5
    s_mul_i32 s53, s40, s46
    s_cmp_eq_u32 s7, 1
    s_cselect_b32 s46, 18, 6
    s_mul_i32 s54, s40, s46
    s_cmp_eq_u32 s7, 1
    s_cselect_b32 s46, 19, 7
    s_mul_i32 s55, s40, s46
    s_mul_i32 s46, s41, s40
    v_mul_lo_u32 v5, v2, s46
    v_lshl_add_u32 v5, v3, 1, v5
    v_add_u32 v5, s42, v5
    v_lshlrev_b32 v6, 4, v1
    s_mov_b32 s47, s3
    s_add_u32 s58, s47, 0
    s_cmp_ge_u32 s58, s44
    s_cbranch_scc1 P_ld_done
    s_add_u32 s56, s43, s58
    s_lshl_b32 s56, s56, 5
    s_mul_i32 s56, s56, s40
    v_add_u32 v7, s56, v5
    buffer_load_ushort v16, v7, s[8:11], s48 offen
    buffer_load_ushort v17, v7, s[8:11], s49 offen
    buffer_load_ushort v18, v7, s[8:11], s50 offen
    buffer_load_ushort v19, v7, s[8:11], s51 offen
    buffer_load_ushort v20, v7, s[8:11], s52 offen
    buffer_load_ushort v21, v7, s[8:11], s53 offen
    buffer_load_ushort v22, v7, s[8:11], s54 offen
    buffer_load_ushort v23, v7, s[8:11], s55 offen
    s_add_u32 s58, s47, 4
    s_cmp_ge_u32 s58, s44
    s_cbranch_scc1 P_ld_done
    s_add_u32 s56, s43, s58
    s_lshl_b32 s56, s56, 5
    s_mul_i32 s56, s56, s40
    v_add_u32 v7, s56, v5
    buffer_load_ushort v24, v7, s[8:11], s48 offen
    buffer_load_ushort v25, v7, s[8:11], s49 offen
    buffer_load_ushort v26, v7, s[8:11], s50 offen
    buffer_load_ushort v27, v7, s[8:11], s51 offen
    buffer_load_ushort v28, v7, s[8:11], s52 offen
    buffer_load_ushort v29, v7, s[8:11], s53 offen
    buffer_load_ushort v30, v7, s[8:11], s54 offen
    buffer_load_ushort v31, v7, s[8:11], s55 offen
    s_add_u32 s58, s47, 8
    s_cmp_ge_u32 s58, s44
    s_cbranch_scc1 P_ld_done
    s_add_u32 s56, s43, s58
    s_lshl_b32 s56, s56, 5
    s_mul_i32 s56, s56, s40
    v_add_u32 v7, s56, v5
    buffer_load_ushort v32, v7, s[8:11], s48 offen
    buffer_load_ushort v33, v7, s[8:11], s49 offen
    buffer_load_ushort v34, v7, s[8:11], s50 offen
    buffer_load_ushort v35, v7, s[8:11], s51 offen
    buffer_load_ushort v36, v7, s[8:11], s52 offen
    buffer_load_ushort v37, v7, s[8:11], s53 offen
    buffer_load_ushort v38, v7, s[8:11], s54 offen
    buffer_load_ushort v39, v7, s[8:11], s55 offen
    s_add_u32 s58, s47, 12
    s_cmp_ge_u32 s58, s44
    s_cbranch_scc1 P_ld_done
    s_add_u32 s56, s43, s58
    s_lshl_b32 s56, s56, 5
    s_mul_i32 s56, s56, s40
    v_add_u32 v7, s56, v5
    buffer_load_ushort v40, v7, s[8:11], s48 offen
    buffer_load_ushort v41, v7, s[8:11], s49 offen
    buffer_load_ushort v42, v7, s[8:11], s50 offen
    buffer_load_ushort v43, v7, s[8:11], s51 offen
    buffer_load_ushort v44, v7, s[8:11], s52 offen
    buffer_load_ushort v45, v7, s[8:11], s53 offen
    buffer_load_ushort v46, v7, s[8:11], s54 offen
    buffer_load_ushort v47, v7, s[8:11], s55 offen
P_ld_done:
    s_waitcnt vmcnt(0)
    s_add_u32 s58, s47, 0
    s_cmp_ge_u32 s58, s44
    s_cbranch_scc1 P_end
    s_lshl_b32 s57, s58, 10
    s_add_u32 s57, s57, s45
    v_lshl_or_b32 v48, v17, 16, v16
    v_lshl_or_b32 v49, v19, 16, v18
    v_lshl_or_b32 v50, v21, 16, v20
    v_lshl_or_b32 v51, v23, 16, v22
    buffer_store_dwordx4 v[48:51], v6, s[12:15], s57 offen
    s_add_u32 s58, s47, 4
    s_cmp_ge_u32 s58, s44
    s_cbranch_scc1 P_end
    s_lshl_b32 s57, s58, 10
    s_add_u32 s57, s57, s45
    v_lshl_or_b32 v52, v25, 16, v24
    v_lshl_or_b32 v53, v27, 16, v26
    v_lshl_or_b32 v54, v29, 16, v28
    v_lshl_or_b32 v55, v31, 16, v30
    buffer_store_dwordx4 v[52:55], v6, s[12:15], s57 offen
    s_add_u32 s58, s47, 8
    s_cmp_ge_u32 s58, s44
    s_cbranch_scc1 P_end
    s_lshl_b32 s57, s58, 10
    s_add_u32 s57, s57, s45
    v_lshl_or_b32 v56, v33, 16, v32
    v_lshl_or_b32 v57, v35, 16, v34
    v_lshl_or_b32 v58, v37, 16, v36
    v_lshl_or_b32 v59, v39, 16, v38
    buffer_store_dwordx4 v[56:59], v6, s[12:15], s57 offen
    s_add_u32 s58, s47, 12
    s_cmp_ge_u32 s58, s44
    s_cbranch_scc1 P_end
    s_lshl_b32 s57, s58, 10
    s_add_u32 s57, s57, s45
    v_lshl_or_b32 v60, v41, 16, v40
    v_lshl_or_b32 v61, v43, 16, v42
    v_lshl_or_b32 v62, v45, 16, v44
    v_lshl_or_b32 v63, v47, 16, v46
    buffer_store_dwordx4 v[60:63], v6, s[12:15], s57 offen
    s_branch P_end
P_zero:
    s_sub_u32 s4, s2, 1888
    s_lshl_b32 s4, s4, 14
    s_add_u32 s4, s4, 0x8000000
    v_lshlrev_b32 v6, 6, v0
    v_mov_b32 v8, 0
    v_mov_b32 v9, 0
    v_mov_b32 v10, 0
    v_mov_b32 v11, 0
    buffer_store_dwordx4 v[8:11], v6, s[12:15], s4 offen
    buffer_store_dwordx4 v[8:11], v6, s[12:15], s4 offen offset:16
    buffer_store_dwordx4 v[8:11], v6, s[12:15], s4 offen offset:32
    buffer_store_dwordx4 v[8:11], v6, s[12:15], s4 offen offset:48
    s_endpgm
P_ln:
    s_mov_b32 s8, s20
    s_mov_b32 s9, s21
    s_mov_b32 s10, 0x200000
    s_mov_b32 s11, 0x20000
    s_lshl_b32 s4, s2, 2
    s_add_u32 s4, s4, s3
    s_lshl_b32 s5, s4, 10
    v_lshlrev_b32 v6, 4, v1
    buffer_load_dwordx4 v[8:11], v6, s[8:11], s5 offen
    v_xor_b32 v5, 32, v1
    v_lshlrev_b32 v5, 2, v5
    s_waitcnt vmcnt(0)
    v_lshlrev_b32 v16, 16, v8
    v_and_b32 v17, 0xffff0000, v8
    v_lshlrev_b32 v18, 16, v9
    v_and_b32 v19, 0xffff0000, v9
    v_lshlrev_b32 v20, 16, v10
    v_and_b32 v21, 0xffff0000, v10
    v_lshlrev_b32 v22, 16, v11
    v_and_b32 v23, 0xffff0000, v11
    v_add_f32 v24, v16, v17
    v_add_f32 v24, v24, v18
    v_add_f32 v24, v24, v19
    v_add_f32 v24, v24, v20
    v_add_f32 v24, v24, v21
    v_add_f32 v24, v24, v22
    v_add_f32 v24, v24, v23
    ds_swizzle_b32 v27, v24 offset:0x41f
    s_waitcnt lgkmcnt(0)
    v_add_f32 v24, v24, v27
    ds_swizzle_b32 v27, v24 offset:0x81f
    s_waitcnt lgkmcnt(0)
    v_add_f32 v24, v24, v27
    ds_swizzle_b32 v27, v24 offset:0x101f
    s_waitcnt lgkmcnt(0)
    v_add_f32 v24, v24, v27
    ds_swizzle_b32 v27, v24 offset:0x201f
    s_waitcnt lgkmcnt(0)
    v_add_f32 v24, v24, v27
    ds_swizzle_b32 v27, v24 offset:0x401f
    s_waitcnt lgkmcnt(0)
    v_add_f32 v24, v24, v27
    ds_bpermute_b32 v27, v5, v24
    s_waitcnt lgkmcnt(0)
    v_add_f32 v24, v24, v27
    v_mul_f32 v26, 0x3b000000, v24
    v_sub_f32 v27, v16, v26
    v_mul_f32 v25, v27, v27
    v_sub_f32 v27, v17, v26
    v_fmac_f32 v25, v27, v27
    v_sub_f32 v27, v18, v26
    v_fmac_f32 v25, v27, v27
    v_sub_f32 v27, v19, v26
    v_fmac_f32 v25, v27, v27
    v_sub_f32 v27, v20, v26
    v_fmac_f32 v25, v27, v27
    v_sub_f32 v27, v21, v26
    v_fmac_f32 v25, v27, v27
    v_sub_f32 v27, v22, v26
    v_fmac_f32 v25, v27, v27
    v_sub_f32 v27, v23, v26
    v_fmac_f32 v25, v27, v27
    ds_swizzle_b32 v27, v25 offset:0x41f
    s_waitcnt lgkmcnt(0)
    v_add_f32 v25, v25, v27
    ds_swizzle_b32 v27, v25 offset:0x81f
    s_waitcnt lgkmcnt(0)
    v_add_f32 v25, v25, v27
    ds_swizzle_b32 v27, v25 offset:0x101f
    s_waitcnt lgkmcnt(0)
    v_add_f32 v25, v25, v27
    ds_swizzle_b32 v27, v25 offset:0x201f
    s_waitcnt lgkmcnt(0)
    v_add_f32 v25, v25, v27
    ds_swizzle_b32 v27, v25 offset:0x401f
    s_waitcnt lgkmcnt(0)
    v_add_f32 v25, v25, v27
    ds_bpermute_b32 v27, v5, v25
    s_waitcnt lgkmcnt(0)
    v_add_f32 v25, v25, v27
    v_mul_f32 v25, 0x3b000000, v25
    v_cvt_pk_bf16_f32 v27, v26, v26
    v_lshlrev_b32 v26, 16, v27
    v_cvt_pk_bf16_f32 v27, v25, v25
    v_lshlrev_b32 v25, 16, v27
    v_add_f32 v25, 0x3727c5ac, v25
    v_cvt_pk_bf16_f32 v27, v25, v25
    v_lshlrev_b32 v25, 16, v27
    v_sqrt_f32 v25, v25
    s_nop 1
    v_cvt_pk_bf16_f32 v27, v25, v25
    v_lshlrev_b32 v25, 16, v27
    v_rcp_f32 v25, v25
    s_nop 1
    v_sub_f32 v16, v16, v26
    v_sub_f32 v17, v17, v26
    v_sub_f32 v18, v18, v26
    v_sub_f32 v19, v19, v26
    v_sub_f32 v20, v20, v26
    v_sub_f32 v21, v21, v26
    v_sub_f32 v22, v22, v26
    v_sub_f32 v23, v23, v26
    v_cvt_pk_bf16_f32 v27, v16, v17
    v_lshlrev_b32 v16, 16, v27
    v_and_b32 v17, 0xffff0000, v27
    v_mul_f32 v16, v16, v25
    v_mul_f32 v17, v17, v25
    v_cvt_pk_bf16_f32 v27, v18, v19
    v_lshlrev_b32 v18, 16, v27
    v_and_b32 v19, 0xffff0000, v27
    v_mul_f32 v18, v18, v25
    v_mul_f32 v19, v19, v25
    v_cvt_pk_bf16_f32 v27, v20, v21
    v_lshlrev_b32 v20, 16, v27
    v_and_b32 v21, 0xffff0000, v27
    v_mul_f32 v20, v20, v25
    v_mul_f32 v21, v21, v25
    v_cvt_pk_bf16_f32 v27, v22, v23
    v_lshlrev_b32 v22, 16, v27
    v_and_b32 v23, 0xffff0000, v27
    v_mul_f32 v22, v22, v25
    v_mul_f32 v23, v23, v25
    v_cvt_pk_bf16_f32 v8, v16, v17
    v_cvt_pk_bf16_f32 v9, v18, v19
    v_cvt_pk_bf16_f32 v10, v20, v21
    v_cvt_pk_bf16_f32 v11, v22, v23
    s_lshr_b32 s5, s4, 4
    s_lshl_b32 s5, s5, 14
    s_and_b32 s6, s4, 15
    s_lshl_b32 s6, s6, 4
    s_add_u32 s5, s5, s6
    s_add_u32 s5, s5, 0x0
    v_lshrrev_b32 v6, 2, v1
    v_lshlrev_b32 v6, 10, v6
    v_and_b32 v7, 3, v1
    v_lshl_add_u32 v6, v7, 8, v6
    buffer_store_dwordx4 v[8:11], v6, s[12:15], s5 offen
P_end:
    s_endpgm
.globl rec_kernel
.p2align 8
.type rec_kernel,@function
rec_kernel:
    s_load_dwordx2 s[38:39], s[0:1], 104
    s_load_dwordx2 s[20:21], s[0:1], 8
    s_load_dwordx2 s[80:81], s[0:1], 96
    v_and_b32 v1, 63, v0
    v_lshrrev_b32 v2, 4, v1
    v_and_b32 v3, 15, v1
    v_lshrrev_b32 v4, 6, v0
    s_nop 0
    v_readfirstlane_b32 s3, v4
    s_waitcnt lgkmcnt(0)
    s_mov_b32 s12, s38
    s_mov_b32 s13, s39
    s_mov_b32 s14, 0x10000000
    s_mov_b32 s15, 0x20000
    s_mov_b32 s8, s20
    s_mov_b32 s9, s21
    s_mov_b32 s10, 0x2000
    s_mov_b32 s11, 0x20000
    s_mov_b32 s82, 256
    s_mov_b32 s83, 0x20000
    s_getreg_b32 s40, hwreg(HW_REG_XCC_ID)
    s_and_b32 s40, s40, 15
    s_cmp_lg_u32 s3, 0
    s_cbranch_scc1 E_w0done
    s_mov_b64 exec, 1
    v_mov_b32 v84, 1
    v_mov_b32 v85, 1
    s_lshl_b32 s4, s40, 2
    v_mov_b32 v86, s4
    v_mov_b32 v87, 64
    buffer_atomic_add v84, v86, s[80:83], 0 offen sc0 sc1
    buffer_atomic_add v85, v87, s[80:83], 0 offen sc0 sc1
    s_waitcnt vmcnt(0)
    v_readfirstlane_b32 s41, v84
    v_readfirstlane_b32 s42, v85
    s_mov_b32 s43, 0xfe
    s_cmp_lt_u32 s41, 32
    s_cbranch_scc1 E_cand
    s_cmp_lt_u32 s42, 32
    s_cbranch_scc0 E_bcast
    E_cand:
    v_mov_b32 v87, 128
    s_cmp_lg_u32 s41, 31
    s_cbranch_scc1 E_poll0
    s_add_u32 s4, s40, 1
    v_mov_b32 v84, s4
    v_mov_b32 v85, 0
    buffer_atomic_cmpswap v[84:85], v87, s[80:83], 0 offen sc0 sc1
    s_waitcnt vmcnt(0)
    E_poll0:
    s_mov_b32 s5, 0
    E_poll:
    buffer_load_dword v84, v87, s[80:83], 0 offen sc1
    s_waitcnt vmcnt(0)
    v_readfirstlane_b32 s43, v84
    s_cmp_lg_u32 s43, 0
    s_cbranch_scc1 E_bcast
    s_add_u32 s5, s5, 1
    s_cmp_lt_u32 s5, 4000
    s_cbranch_scc1 E_poll
    v_mov_b32 v84, 0xff
    v_mov_b32 v85, 0
    buffer_atomic_cmpswap v[84:85], v87, s[80:83], 0 offen sc0 sc1
    s_waitcnt vmcnt(0)
    v_readfirstlane_b32 s43, v84
    s_cmp_lg_u32 s43, 0
    s_cbranch_scc1 E_bcast
    s_mov_b32 s43, 0xff
    E_bcast:
    v_mov_b32 v84, s41
    v_mov_b32 v85, s42
    v_mov_b32 v86, s43
    v_mov_b32 v87, 0
    ds_write_b96 v87, v[84:86]
    s_mov_b64 exec, -1
    E_w0done:
    s_waitcnt lgkmcnt(0)
    s_barrier
    v_mov_b32 v87, 0
    ds_read_b96 v[84:86], v87
    s_waitcnt lgkmcnt(0)
    v_readfirstlane_b32 s41, v84
    v_readfirstlane_b32 s42, v85
    v_readfirstlane_b32 s43, v86
    s_barrier
    s_add_u32 s4, s40, 1
    s_mov_b32 s44, 1
    s_mov_b32 s2, s41
    s_cmp_eq_u32 s43, s4
    s_cbranch_scc1 E_chk
    s_mov_b32 s44, 0
    s_mov_b32 s2, s42
    s_cmp_eq_u32 s43, 0xff
    s_cbranch_scc0 W_loop
    E_chk:
    s_cmp_ge_u32 s2, 32
    s_cbranch_scc1 W_loop
    v_lshlrev_b32 v4, 4, v1
    v_xor_b32 v5, 32, v1
    v_lshlrev_b32 v5, 2, v5
    v_and_b32 v19, 7, v1
    v_add_u32 v6, 14720, v4
    v_mul_u32_u24 v8, 272, v19
    v_lshl_add_u32 v8, v2, 4, v8
    v_lshlrev_b32 v9, 4, v3
    v_lshl_add_u32 v9, v2, 3, v9
    v_add_u32 v9, 12672, v9
    v_mul_u32_u24 v10, 1040, v19
    v_lshl_add_u32 v10, v2, 4, v10
    v_add_u32 v10, 0, v10
    v_mul_u32_u24 v11, 272, v3
    v_lshl_add_u32 v11, v2, 3, v11
    s_lshl_b32 s4, s3, 6
    v_add_u32 v11, s4, v11
    v_lshlrev_b32 v12, 4, v3
    v_lshl_add_u32 v12, v2, 3, v12
    s_lshl_b32 s4, s3, 9
    s_add_u32 s4, s4, 12672
    v_add_u32 v12, s4, v12
    v_lshlrev_b32 v13, 8, v3
    v_lshl_add_u32 v13, v2, 3, v13
    s_lshl_b32 s4, s2, 11
    s_lshl_b32 s5, s3, 6
    s_add_u32 s4, s4, s5
    v_add_u32 v13, s4, v13
    s_lshl_b32 s4, s2, 8
    s_add_u32 s4, s4, s5
    v_lshlrev_b32 v14, 4, v3
    v_lshl_add_u32 v14, v2, 3, v14
    s_lshl_b32 s4, s4, 3
    v_add_u32 v14, s4, v14
    s_lshl_b32 s4, s3, 17
    s_lshl_b32 s5, s2, 10
    s_add_u32 s4, s4, s5
    v_lshlrev_b32 v15, 6, v3
    v_and_b32 v17, 1, v2
    v_lshl_add_u32 v15, v17, 5, v15
    v_lshrrev_b32 v17, 5, v1
    v_lshl_add_u32 v15, v17, 4, v15
    v_add_u32 v15, s4, v15
    v_lshlrev_b32 v16, 4, v3
    v_lshl_add_u32 v16, v2, 13, v16
    s_lshr_b32 s4, s2, 1
    s_lshl_b32 s4, s4, 15
    s_and_b32 s5, s2, 1
    s_lshl_b32 s5, s5, 3
    s_add_u32 s4, s4, s5
    s_lshl_b32 s5, s3, 8
    s_add_u32 s4, s4, s5
    v_add_u32 v16, s4, v16
    v_lshlrev_b32 v17, 4, v0
    v_and_b32 v18, 1, v0
    v_mul_u32_u24 v18, 4160, v18
    v_lshrrev_b32 v100, 5, v0
    v_lshl_add_u32 v18, v100, 5, v18
    v_and_b32 v100, 31, v0
    v_lshrrev_b32 v100, 1, v100
    v_lshl_add_u32 v18, v100, 1, v18
    v_add_u32 v18, 0, v18
    v_cmp_gt_u32 s[30:31], 8, v3
    v_cmp_gt_u32 s[32:33], 32, v1
    s_lshl_b32 s34, s3, 12
    s_add_u32 s34, s34, 14720
    s_lshl_b32 s35, s2, 14
    s_lshl_b32 s4, s3, 12
    s_add_u32 s35, s35, s4
    s_add_u32 s35, s35, 0x2800000
    s_lshl_b32 s4, s2, 17
    s_lshl_b32 s5, s3, 15
    s_add_u32 s4, s4, s5
    v_add_u32 v88, s4, v4
    s_mov_b32 s4, 0x200000
    buffer_load_dwordx4 a[0:3], v88, s[12:15], s4 offen
    s_mov_b32 s4, 0x200400
    buffer_load_dwordx4 a[4:7], v88, s[12:15], s4 offen
    s_mov_b32 s4, 0x200800
    buffer_load_dwordx4 a[8:11], v88, s[12:15], s4 offen
    s_mov_b32 s4, 0x200c00
    buffer_load_dwordx4 a[12:15], v88, s[12:15], s4 offen
    s_mov_b32 s4, 0x201000
    buffer_load_dwordx4 a[16:19], v88, s[12:15], s4 offen
    s_mov_b32 s4, 0x201400
    buffer_load_dwordx4 a[20:23], v88, s[12:15], s4 offen
    s_mov_b32 s4, 0x201800
    buffer_load_dwordx4 a[24:27], v88, s[12:15], s4 offen
    s_mov_b32 s4, 0x201c00
    buffer_load_dwordx4 a[28:31], v88, s[12:15], s4 offen
    s_mov_b32 s4, 0x202000
    buffer_load_dwordx4 a[32:35], v88, s[12:15], s4 offen
    s_mov_b32 s4, 0x202400
    buffer_load_dwordx4 a[36:39], v88, s[12:15], s4 offen
    s_mov_b32 s4, 0x202800
    buffer_load_dwordx4 a[40:43], v88, s[12:15], s4 offen
    s_mov_b32 s4, 0x202c00
    buffer_load_dwordx4 a[44:47], v88, s[12:15], s4 offen
    s_mov_b32 s4, 0x203000
    buffer_load_dwordx4 a[48:51], v88, s[12:15], s4 offen
    s_mov_b32 s4, 0x203400
    buffer_load_dwordx4 a[52:55], v88, s[12:15], s4 offen
    s_mov_b32 s4, 0x203800
    buffer_load_dwordx4 a[56:59], v88, s[12:15], s4 offen
    s_mov_b32 s4, 0x203c00
    buffer_load_dwordx4 a[60:63], v88, s[12:15], s4 offen
    s_mov_b32 s4, 0x204000
    buffer_load_dwordx4 a[64:67], v88, s[12:15], s4 offen
    s_mov_b32 s4, 0x204400
    buffer_load_dwordx4 a[68:71], v88, s[12:15], s4 offen
    s_mov_b32 s4, 0x204800
    buffer_load_dwordx4 a[72:75], v88, s[12:15], s4 offen
    s_mov_b32 s4, 0x204c00
    buffer_load_dwordx4 a[76:79], v88, s[12:15], s4 offen
    s_mov_b32 s4, 0x205000
    buffer_load_dwordx4 a[80:83], v88, s[12:15], s4 offen
    s_mov_b32 s4, 0x205400
    buffer_load_dwordx4 a[84:87], v88, s[12:15], s4 offen
    s_mov_b32 s4, 0x205800
    buffer_load_dwordx4 a[88:91], v88, s[12:15], s4 offen
    s_mov_b32 s4, 0x205c00
    buffer_load_dwordx4 a[92:95], v88, s[12:15], s4 offen
    s_mov_b32 s4, 0x206000
    buffer_load_dwordx4 a[96:99], v88, s[12:15], s4 offen
    s_mov_b32 s4, 0x206400
    buffer_load_dwordx4 a[100:103], v88, s[12:15], s4 offen
    s_mov_b32 s4, 0x206800
    buffer_load_dwordx4 a[104:107], v88, s[12:15], s4 offen
    s_mov_b32 s4, 0x206c00
    buffer_load_dwordx4 a[108:111], v88, s[12:15], s4 offen
    s_mov_b32 s4, 0x207000
    buffer_load_dwordx4 a[112:115], v88, s[12:15], s4 offen
    s_mov_b32 s4, 0x207400
    buffer_load_dwordx4 a[116:119], v88, s[12:15], s4 offen
    s_mov_b32 s4, 0x207800
    buffer_load_dwordx4 a[120:123], v88, s[12:15], s4 offen
    s_mov_b32 s4, 0x207c00
    buffer_load_dwordx4 a[124:127], v88, s[12:15], s4 offen
    s_mov_b32 s4, 0x600000
    buffer_load_dwordx4 a[128:131], v88, s[12:15], s4 offen
    s_mov_b32 s4, 0x600400
    buffer_load_dwordx4 a[132:135], v88, s[12:15], s4 offen
    s_mov_b32 s4, 0x600800
    buffer_load_dwordx4 a[136:139], v88, s[12:15], s4 offen
    s_mov_b32 s4, 0x600c00
    buffer_load_dwordx4 a[140:143], v88, s[12:15], s4 offen
    s_mov_b32 s4, 0x601000
    buffer_load_dwordx4 a[144:147], v88, s[12:15], s4 offen
    s_mov_b32 s4, 0x601400
    buffer_load_dwordx4 a[148:151], v88, s[12:15], s4 offen
    s_mov_b32 s4, 0x601800
    buffer_load_dwordx4 a[152:155], v88, s[12:15], s4 offen
    s_mov_b32 s4, 0x601c00
    buffer_load_dwordx4 a[156:159], v88, s[12:15], s4 offen
    s_mov_b32 s4, 0x602000
    buffer_load_dwordx4 a[160:163], v88, s[12:15], s4 offen
    s_mov_b32 s4, 0x602400
    buffer_load_dwordx4 a[164:167], v88, s[12:15], s4 offen
    s_mov_b32 s4, 0x602800
    buffer_load_dwordx4 a[168:171], v88, s[12:15], s4 offen
    s_mov_b32 s4, 0x602c00
    buffer_load_dwordx4 a[172:175], v88, s[12:15], s4 offen
    s_mov_b32 s4, 0x603000
    buffer_load_dwordx4 a[176:179], v88, s[12:15], s4 offen
    s_mov_b32 s4, 0x603400
    buffer_load_dwordx4 a[180:183], v88, s[12:15], s4 offen
    s_mov_b32 s4, 0x603800
    buffer_load_dwordx4 a[184:187], v88, s[12:15], s4 offen
    s_mov_b32 s4, 0x603c00
    buffer_load_dwordx4 a[188:191], v88, s[12:15], s4 offen
    s_mov_b32 s4, 0x604000
    buffer_load_dwordx4 a[192:195], v88, s[12:15], s4 offen
    s_mov_b32 s4, 0x604400
    buffer_load_dwordx4 a[196:199], v88, s[12:15], s4 offen
    s_mov_b32 s4, 0x604800
    buffer_load_dwordx4 a[200:203], v88, s[12:15], s4 offen
    s_mov_b32 s4, 0x604c00
    buffer_load_dwordx4 a[204:207], v88, s[12:15], s4 offen
    s_mov_b32 s4, 0x605000
    buffer_load_dwordx4 a[208:211], v88, s[12:15], s4 offen
    s_mov_b32 s4, 0x605400
    buffer_load_dwordx4 a[212:215], v88, s[12:15], s4 offen
    s_mov_b32 s4, 0x605800
    buffer_load_dwordx4 a[216:219], v88, s[12:15], s4 offen
    s_mov_b32 s4, 0x605c00
    buffer_load_dwordx4 a[220:223], v88, s[12:15], s4 offen
    s_mov_b32 s4, 0x606000
    buffer_load_dwordx4 a[224:227], v88, s[12:15], s4 offen
    s_mov_b32 s4, 0x606400
    buffer_load_dwordx4 a[228:231], v88, s[12:15], s4 offen
    s_mov_b32 s4, 0x606800
    buffer_load_dwordx4 a[232:235], v88, s[12:15], s4 offen
    s_mov_b32 s4, 0x606c00
    buffer_load_dwordx4 a[236:239], v88, s[12:15], s4 offen
    s_mov_b32 s4, 0x607000
    buffer_load_dwordx4 a[240:243], v88, s[12:15], s4 offen
    s_mov_b32 s4, 0x607400
    buffer_load_dwordx4 a[244:247], v88, s[12:15], s4 offen
    s_mov_b32 s4, 0x607800
    buffer_load_dwordx4 a[248:251], v88, s[12:15], s4 offen
    s_mov_b32 s4, 0x607c00
    buffer_load_dwordx4 a[252:255], v88, s[12:15], s4 offen
    s_mov_b32 s4, 0xa00000
    buffer_load_dwordx4 v[128:131], v88, s[12:15], s4 offen
    s_mov_b32 s4, 0xa00400
    buffer_load_dwordx4 v[132:135], v88, s[12:15], s4 offen
    s_mov_b32 s4, 0xa00800
    buffer_load_dwordx4 v[136:139], v88, s[12:15], s4 offen
    s_mov_b32 s4, 0xa00c00
    buffer_load_dwordx4 v[140:143], v88, s[12:15], s4 offen
    s_mov_b32 s4, 0xa01000
    buffer_load_dwordx4 v[144:147], v88, s[12:15], s4 offen
    s_mov_b32 s4, 0xa01400
    buffer_load_dwordx4 v[148:151], v88, s[12:15], s4 offen
    s_mov_b32 s4, 0xa01800
    buffer_load_dwordx4 v[152:155], v88, s[12:15], s4 offen
    s_mov_b32 s4, 0xa01c00
    buffer_load_dwordx4 v[156:159], v88, s[12:15], s4 offen
    s_mov_b32 s4, 0xa02000
    buffer_load_dwordx4 v[160:163], v88, s[12:15], s4 offen
    s_mov_b32 s4, 0xa02400
    buffer_load_dwordx4 v[164:167], v88, s[12:15], s4 offen
    s_mov_b32 s4, 0xa02800
    buffer_load_dwordx4 v[168:171], v88, s[12:15], s4 offen
    s_mov_b32 s4, 0xa02c00
    buffer_load_dwordx4 v[172:175], v88, s[12:15], s4 offen
    s_mov_b32 s4, 0xa03000
    buffer_load_dwordx4 v[176:179], v88, s[12:15], s4 offen
    s_mov_b32 s4, 0xa03400
    buffer_load_dwordx4 v[180:183], v88, s[12:15], s4 offen
    s_mov_b32 s4, 0xa03800
    buffer_load_dwordx4 v[184:187], v88, s[12:15], s4 offen
    s_mov_b32 s4, 0xa03c00
    buffer_load_dwordx4 v[188:191], v88, s[12:15], s4 offen
    s_mov_b32 s4, 0xa04000
    buffer_load_dwordx4 v[192:195], v88, s[12:15], s4 offen
    s_mov_b32 s4, 0xa04400
    buffer_load_dwordx4 v[196:199], v88, s[12:15], s4 offen
    s_mov_b32 s4, 0xa04800
    buffer_load_dwordx4 v[200:203], v88, s[12:15], s4 offen
    s_mov_b32 s4, 0xa04c00
    buffer_load_dwordx4 v[204:207], v88, s[12:15], s4 offen
    s_mov_b32 s4, 0xa05000
    buffer_load_dwordx4 v[208:211], v88, s[12:15], s4 offen
    s_mov_b32 s4, 0xa05400
    buffer_load_dwordx4 v[212:215], v88, s[12:15], s4 offen
    s_mov_b32 s4, 0xa05800
    buffer_load_dwordx4 v[216:219], v88, s[12:15], s4 offen
    s_mov_b32 s4, 0xa05c00
    buffer_load_dwordx4 v[220:223], v88, s[12:15], s4 offen
    s_mov_b32 s4, 0xa06000
    buffer_load_dwordx4 v[224:227], v88, s[12:15], s4 offen
    s_mov_b32 s4, 0xa06400
    buffer_load_dwordx4 v[228:231], v88, s[12:15], s4 offen
    s_mov_b32 s4, 0xa06800
    buffer_load_dwordx4 v[232:235], v88, s[12:15], s4 offen
    s_mov_b32 s4, 0xa06c00
    buffer_load_dwordx4 v[236:239], v88, s[12:15], s4 offen
    s_mov_b32 s4, 0xa07000
    buffer_load_dwordx4 v[240:243], v88, s[12:15], s4 offen
    s_mov_b32 s4, 0xa07400
    buffer_load_dwordx4 v[244:247], v88, s[12:15], s4 offen
    s_mov_b32 s4, 0xa07800
    buffer_load_dwordx4 v[248:251], v88, s[12:15], s4 offen
    s_mov_b32 s4, 0xa07c00
    buffer_load_dwordx4 v[252:255], v88, s[12:15], s4 offen
    s_lshl_b32 s4, s3, 20
    s_lshl_b32 s5, s2, 12
    s_add_u32 s4, s4, s5
    s_add_u32 s4, s4, 0xe00000
    s_lshl_b32 s5, s3, 15
    s_add_u32 s5, s5, 31104
    s_mov_b32 m0, s5
    s_nop 0
    buffer_load_dwordx4 v4, s[12:15], s4 offen offset:0 lds
    buffer_load_dwordx4 v4, s[12:15], s4 offen offset:1024 lds
    buffer_load_dwordx4 v4, s[12:15], s4 offen offset:2048 lds
    buffer_load_dwordx4 v4, s[12:15], s4 offen offset:3072 lds
    s_add_u32 s4, s4, 131072
    s_add_u32 s5, s5, 4096
    s_mov_b32 m0, s5
    s_nop 0
    buffer_load_dwordx4 v4, s[12:15], s4 offen offset:0 lds
    buffer_load_dwordx4 v4, s[12:15], s4 offen offset:1024 lds
    buffer_load_dwordx4 v4, s[12:15], s4 offen offset:2048 lds
    buffer_load_dwordx4 v4, s[12:15], s4 offen offset:3072 lds
    s_add_u32 s4, s4, 131072
    s_add_u32 s5, s5, 4096
    s_mov_b32 m0, s5
    s_nop 0
    buffer_load_dwordx4 v4, s[12:15], s4 offen offset:0 lds
    buffer_load_dwordx4 v4, s[12:15], s4 offen offset:1024 lds
    buffer_load_dwordx4 v4, s[12:15], s4 offen offset:2048 lds
    buffer_load_dwordx4 v4, s[12:15], s4 offen offset:3072 lds
    s_add_u32 s4, s4, 131072
    s_add_u32 s5, s5, 4096
    s_mov_b32 m0, s5
    s_nop 0
    buffer_load_dwordx4 v4, s[12:15], s4 offen offset:0 lds
    buffer_load_dwordx4 v4, s[12:15], s4 offen offset:1024 lds
    buffer_load_dwordx4 v4, s[12:15], s4 offen offset:2048 lds
    buffer_load_dwordx4 v4, s[12:15], s4 offen offset:3072 lds
    s_add_u32 s4, s4, 131072
    s_add_u32 s5, s5, 4096
    s_mov_b32 m0, s5
    s_nop 0
    buffer_load_dwordx4 v4, s[12:15], s4 offen offset:0 lds
    buffer_load_dwordx4 v4, s[12:15], s4 offen offset:1024 lds
    buffer_load_dwordx4 v4, s[12:15], s4 offen offset:2048 lds
    buffer_load_dwordx4 v4, s[12:15], s4 offen offset:3072 lds
    s_add_u32 s4, s4, 131072
    s_add_u32 s5, s5, 4096
    s_mov_b32 m0, s5
    s_nop 0
    buffer_load_dwordx4 v4, s[12:15], s4 offen offset:0 lds
    buffer_load_dwordx4 v4, s[12:15], s4 offen offset:1024 lds
    buffer_load_dwordx4 v4, s[12:15], s4 offen offset:2048 lds
    buffer_load_dwordx4 v4, s[12:15], s4 offen offset:3072 lds
    s_add_u32 s4, s4, 131072
    s_add_u32 s5, s5, 4096
    s_mov_b32 m0, s5
    s_nop 0
    buffer_load_dwordx4 v4, s[12:15], s4 offen offset:0 lds
    buffer_load_dwordx4 v4, s[12:15], s4 offen offset:1024 lds
    buffer_load_dwordx4 v4, s[12:15], s4 offen offset:2048 lds
    buffer_load_dwordx4 v4, s[12:15], s4 offen offset:3072 lds
    s_add_u32 s4, s4, 131072
    s_add_u32 s5, s5, 4096
    s_mov_b32 m0, s5
    s_nop 0
    buffer_load_dwordx4 v4, s[12:15], s4 offen offset:0 lds
    buffer_load_dwordx4 v4, s[12:15], s4 offen offset:1024 lds
    buffer_load_dwordx4 v4, s[12:15], s4 offen offset:2048 lds
    buffer_load_dwordx4 v4, s[12:15], s4 offen offset:3072 lds
    s_add_u32 s4, s4, 131072
    s_add_u32 s5, s5, 4096
    s_mov_b32 s16, 0
    s_and_b32 s4, s16, 3
    s_cmp_lg_u32 s4, 0
    s_cbranch_scc1 KF_2
    s_lshr_b32 s4, s16, 2
    s_lshl_b32 s4, s4, 6
    s_add_u32 s4, s4, s2
    s_lshl_b32 s4, s4, 2
    s_add_u32 s4, s4, 0x8104000
    s_mov_b32 s5, 0
    v_mov_b32 v116, 0
KF_1:
    buffer_load_dword v117, v116, s[12:15], s4 offen sc1
    buffer_load_dword v118, v116, s[12:15], s4 offen offset:128 sc1
    s_waitcnt vmcnt(0)
    v_and_b32 v117, v117, v118
    s_nop 0
    v_readfirstlane_b32 s6, v117
    s_add_u32 s5, s5, 1
    s_cmp_ge_u32 s5, 0x40000
    s_cbranch_scc1 KF_2
    s_cmp_eq_u32 s6, 0
    s_cbranch_scc1 KF_1
KF_2:
    s_mov_b32 m0, s34
    s_nop 0
    buffer_load_dwordx4 v4, s[12:15], s35 offen offset:0 sc1 lds
    buffer_load_dwordx4 v4, s[12:15], s35 offen offset:1024 sc1 lds
    buffer_load_dwordx4 v4, s[12:15], s35 offen offset:2048 sc1 lds
    buffer_load_dwordx4 v4, s[12:15], s35 offen offset:3072 sc1 lds
    s_add_u32 s35, s35, 0x80000
R_loop:
    s_cmp_lg_u32 s16, 0
    s_cbranch_scc1 R_poll2
    v_lshlrev_b32 v84, 5, v0
    buffer_load_dwordx4 v[88:91], v84, s[8:11], 0 offen
    buffer_load_dwordx4 v[92:95], v84, s[8:11], 0 offen offset:16
    v_lshrrev_b32 v85, 5, v0
    v_mul_u32_u24 v85, 1040, v85
    v_and_b32 v86, 31, v0
    v_lshl_add_u32 v85, v86, 5, v85
    v_add_u32 v85, 0, v85
    s_waitcnt vmcnt(0)
    ds_write_b128 v85, v[88:91]
    ds_write_b128 v85, v[92:95] offset:16
    s_branch R_memdone
R_poll2:
    s_waitcnt vmcnt(0)
    s_mov_b32 s17, 0
    s_mov_b32 s18, 0x8100000
    s_add_u32 s22, s18, 4096
    s_add_u32 s23, s18, 8192
    s_add_u32 s24, s18, 12288
R_p2loop:
    buffer_load_dwordx4 v[84:87], v17, s[12:15], s18 offen sc1
    buffer_load_dwordx4 v[88:91], v17, s[12:15], s22 offen sc1
    buffer_load_dwordx4 v[92:95], v17, s[12:15], s23 offen sc1
    buffer_load_dwordx4 v[96:99], v17, s[12:15], s24 offen sc1
    s_waitcnt vmcnt(0)
    v_xor_b32 v100, s16, v85
    v_xor_b32 v101, s16, v87
    v_or_b32 v100, v100, v101
    v_xor_b32 v101, s16, v89
    v_or_b32 v100, v100, v101
    v_xor_b32 v101, s16, v91
    v_or_b32 v100, v100, v101
    v_xor_b32 v101, s16, v93
    v_or_b32 v100, v100, v101
    v_xor_b32 v101, s16, v95
    v_or_b32 v100, v100, v101
    v_xor_b32 v101, s16, v97
    v_or_b32 v100, v100, v101
    v_xor_b32 v101, s16, v99
    v_or_b32 v100, v100, v101
    v_cmp_ne_u32 vcc, 0, v100
    s_add_u32 s17, s17, 1
    s_cmp_ge_u32 s17, 32768
    s_cbranch_scc1 R_p2done
    s_cbranch_vccnz R_p2loop
R_p2done:
    ds_write_b16 v18, v84 offset:0
    ds_write_b16_d16_hi v18, v84 offset:1040
    ds_write_b16 v18, v86 offset:2080
    ds_write_b16_d16_hi v18, v86 offset:3120
    ds_write_b16 v18, v88 offset:256
    ds_write_b16_d16_hi v18, v88 offset:1296
    ds_write_b16 v18, v90 offset:2336
    ds_write_b16_d16_hi v18, v90 offset:3376
    ds_write_b16 v18, v92 offset:512
    ds_write_b16_d16_hi v18, v92 offset:1552
    ds_write_b16 v18, v94 offset:2592
    ds_write_b16_d16_hi v18, v94 offset:3632
    ds_write_b16 v18, v96 offset:768
    ds_write_b16_d16_hi v18, v96 offset:1808
    ds_write_b16 v18, v98 offset:2848
    ds_write_b16_d16_hi v18, v98 offset:3888
R_memdone:
    s_waitcnt vmcnt(0) lgkmcnt(0)
    s_barrier
    ds_read_b128 v[20:23], v10 offset:0
    ds_read_b128 v[24:27], v10 offset:64
    ds_read_b128 v[28:31], v10 offset:128
    ds_read_b128 v[32:35], v10 offset:192
    ds_read_b128 v[36:39], v10 offset:256
    ds_read_b128 v[40:43], v10 offset:320
    ds_read_b128 v[44:47], v10 offset:384
    ds_read_b128 v[48:51], v10 offset:448
    ds_read_b128 v[52:55], v10 offset:512
    ds_read_b128 v[56:59], v10 offset:576
    ds_read_b128 v[60:63], v10 offset:640
    ds_read_b128 v[64:67], v10 offset:704
    ds_read_b128 v[68:71], v10 offset:768
    ds_read_b128 v[72:75], v10 offset:832
    ds_read_b128 v[76:79], v10 offset:896
    ds_read_b128 v[80:83], v10 offset:960
    s_waitcnt lgkmcnt(15)
    v_mfma_f32_16x16x32_bf16 v[84:87], a[0:3], v[20:23], 0
    v_mfma_f32_16x16x32_bf16 v[88:91], a[64:67], v[20:23], 0
    v_mfma_f32_16x16x32_bf16 v[92:95], a[128:131], v[20:23], 0
    v_mfma_f32_16x16x32_bf16 v[96:99], a[192:195], v[20:23], 0
    v_mfma_f32_16x16x32_bf16 v[100:103], v[20:23], v[128:131], 0
    v_mfma_f32_16x16x32_bf16 v[104:107], v[20:23], v[192:195], 0
    s_waitcnt lgkmcnt(14)
    v_mfma_f32_16x16x32_bf16 v[84:87], a[4:7], v[24:27], v[84:87]
    v_mfma_f32_16x16x32_bf16 v[88:91], a[68:71], v[24:27], v[88:91]
    v_mfma_f32_16x16x32_bf16 v[92:95], a[132:135], v[24:27], v[92:95]
    v_mfma_f32_16x16x32_bf16 v[96:99], a[196:199], v[24:27], v[96:99]
    v_mfma_f32_16x16x32_bf16 v[100:103], v[24:27], v[132:135], v[100:103]
    v_mfma_f32_16x16x32_bf16 v[104:107], v[24:27], v[196:199], v[104:107]
    s_waitcnt lgkmcnt(13)
    v_mfma_f32_16x16x32_bf16 v[84:87], a[8:11], v[28:31], v[84:87]
    v_mfma_f32_16x16x32_bf16 v[88:91], a[72:75], v[28:31], v[88:91]
    v_mfma_f32_16x16x32_bf16 v[92:95], a[136:139], v[28:31], v[92:95]
    v_mfma_f32_16x16x32_bf16 v[96:99], a[200:203], v[28:31], v[96:99]
    v_mfma_f32_16x16x32_bf16 v[100:103], v[28:31], v[136:139], v[100:103]
    v_mfma_f32_16x16x32_bf16 v[104:107], v[28:31], v[200:203], v[104:107]
    s_waitcnt lgkmcnt(12)
    v_mfma_f32_16x16x32_bf16 v[84:87], a[12:15], v[32:35], v[84:87]
    v_mfma_f32_16x16x32_bf16 v[88:91], a[76:79], v[32:35], v[88:91]
    v_mfma_f32_16x16x32_bf16 v[92:95], a[140:143], v[32:35], v[92:95]
    v_mfma_f32_16x16x32_bf16 v[96:99], a[204:207], v[32:35], v[96:99]
    v_mfma_f32_16x16x32_bf16 v[100:103], v[32:35], v[140:143], v[100:103]
    v_mfma_f32_16x16x32_bf16 v[104:107], v[32:35], v[204:207], v[104:107]
    s_waitcnt lgkmcnt(11)
    v_mfma_f32_16x16x32_bf16 v[84:87], a[16:19], v[36:39], v[84:87]
    v_mfma_f32_16x16x32_bf16 v[88:91], a[80:83], v[36:39], v[88:91]
    v_mfma_f32_16x16x32_bf16 v[92:95], a[144:147], v[36:39], v[92:95]
    v_mfma_f32_16x16x32_bf16 v[96:99], a[208:211], v[36:39], v[96:99]
    v_mfma_f32_16x16x32_bf16 v[100:103], v[36:39], v[144:147], v[100:103]
    v_mfma_f32_16x16x32_bf16 v[104:107], v[36:39], v[208:211], v[104:107]
    s_waitcnt lgkmcnt(10)
    v_mfma_f32_16x16x32_bf16 v[84:87], a[20:23], v[40:43], v[84:87]
    v_mfma_f32_16x16x32_bf16 v[88:91], a[84:87], v[40:43], v[88:91]
    v_mfma_f32_16x16x32_bf16 v[92:95], a[148:151], v[40:43], v[92:95]
    v_mfma_f32_16x16x32_bf16 v[96:99], a[212:215], v[40:43], v[96:99]
    v_mfma_f32_16x16x32_bf16 v[100:103], v[40:43], v[148:151], v[100:103]
    v_mfma_f32_16x16x32_bf16 v[104:107], v[40:43], v[212:215], v[104:107]
    s_waitcnt lgkmcnt(9)
    v_mfma_f32_16x16x32_bf16 v[84:87], a[24:27], v[44:47], v[84:87]
    v_mfma_f32_16x16x32_bf16 v[88:91], a[88:91], v[44:47], v[88:91]
    v_mfma_f32_16x16x32_bf16 v[92:95], a[152:155], v[44:47], v[92:95]
    v_mfma_f32_16x16x32_bf16 v[96:99], a[216:219], v[44:47], v[96:99]
    v_mfma_f32_16x16x32_bf16 v[100:103], v[44:47], v[152:155], v[100:103]
    v_mfma_f32_16x16x32_bf16 v[104:107], v[44:47], v[216:219], v[104:107]
    s_waitcnt lgkmcnt(8)
    v_mfma_f32_16x16x32_bf16 v[84:87], a[28:31], v[48:51], v[84:87]
    v_mfma_f32_16x16x32_bf16 v[88:91], a[92:95], v[48:51], v[88:91]
    v_mfma_f32_16x16x32_bf16 v[92:95], a[156:159], v[48:51], v[92:95]
    v_mfma_f32_16x16x32_bf16 v[96:99], a[220:223], v[48:51], v[96:99]
    v_mfma_f32_16x16x32_bf16 v[100:103], v[48:51], v[156:159], v[100:103]
    v_mfma_f32_16x16x32_bf16 v[104:107], v[48:51], v[220:223], v[104:107]
    s_waitcnt lgkmcnt(7)
    v_mfma_f32_16x16x32_bf16 v[84:87], a[32:35], v[52:55], v[84:87]
    v_mfma_f32_16x16x32_bf16 v[88:91], a[96:99], v[52:55], v[88:91]
    v_mfma_f32_16x16x32_bf16 v[92:95], a[160:163], v[52:55], v[92:95]
    v_mfma_f32_16x16x32_bf16 v[96:99], a[224:227], v[52:55], v[96:99]
    v_mfma_f32_16x16x32_bf16 v[100:103], v[52:55], v[160:163], v[100:103]
    v_mfma_f32_16x16x32_bf16 v[104:107], v[52:55], v[224:227], v[104:107]
    s_waitcnt lgkmcnt(6)
    v_mfma_f32_16x16x32_bf16 v[84:87], a[36:39], v[56:59], v[84:87]
    v_mfma_f32_16x16x32_bf16 v[88:91], a[100:103], v[56:59], v[88:91]
    v_mfma_f32_16x16x32_bf16 v[92:95], a[164:167], v[56:59], v[92:95]
    v_mfma_f32_16x16x32_bf16 v[96:99], a[228:231], v[56:59], v[96:99]
    v_mfma_f32_16x16x32_bf16 v[100:103], v[56:59], v[164:167], v[100:103]
    v_mfma_f32_16x16x32_bf16 v[104:107], v[56:59], v[228:231], v[104:107]
    s_waitcnt lgkmcnt(5)
    v_mfma_f32_16x16x32_bf16 v[84:87], a[40:43], v[60:63], v[84:87]
    v_mfma_f32_16x16x32_bf16 v[88:91], a[104:107], v[60:63], v[88:91]
    v_mfma_f32_16x16x32_bf16 v[92:95], a[168:171], v[60:63], v[92:95]
    v_mfma_f32_16x16x32_bf16 v[96:99], a[232:235], v[60:63], v[96:99]
    v_mfma_f32_16x16x32_bf16 v[100:103], v[60:63], v[168:171], v[100:103]
    v_mfma_f32_16x16x32_bf16 v[104:107], v[60:63], v[232:235], v[104:107]
    s_waitcnt lgkmcnt(4)
    v_mfma_f32_16x16x32_bf16 v[84:87], a[44:47], v[64:67], v[84:87]
    v_mfma_f32_16x16x32_bf16 v[88:91], a[108:111], v[64:67], v[88:91]
    v_mfma_f32_16x16x32_bf16 v[92:95], a[172:175], v[64:67], v[92:95]
    v_mfma_f32_16x16x32_bf16 v[96:99], a[236:239], v[64:67], v[96:99]
    v_mfma_f32_16x16x32_bf16 v[100:103], v[64:67], v[172:175], v[100:103]
    v_mfma_f32_16x16x32_bf16 v[104:107], v[64:67], v[236:239], v[104:107]
    s_waitcnt lgkmcnt(3)
    v_mfma_f32_16x16x32_bf16 v[84:87], a[48:51], v[68:71], v[84:87]
    v_mfma_f32_16x16x32_bf16 v[88:91], a[112:115], v[68:71], v[88:91]
    v_mfma_f32_16x16x32_bf16 v[92:95], a[176:179], v[68:71], v[92:95]
    v_mfma_f32_16x16x32_bf16 v[96:99], a[240:243], v[68:71], v[96:99]
    v_mfma_f32_16x16x32_bf16 v[100:103], v[68:71], v[176:179], v[100:103]
    v_mfma_f32_16x16x32_bf16 v[104:107], v[68:71], v[240:243], v[104:107]
    s_waitcnt lgkmcnt(2)
    v_mfma_f32_16x16x32_bf16 v[84:87], a[52:55], v[72:75], v[84:87]
    v_mfma_f32_16x16x32_bf16 v[88:91], a[116:119], v[72:75], v[88:91]
    v_mfma_f32_16x16x32_bf16 v[92:95], a[180:183], v[72:75], v[92:95]
    v_mfma_f32_16x16x32_bf16 v[96:99], a[244:247], v[72:75], v[96:99]
    v_mfma_f32_16x16x32_bf16 v[100:103], v[72:75], v[180:183], v[100:103]
    v_mfma_f32_16x16x32_bf16 v[104:107], v[72:75], v[244:247], v[104:107]
    s_waitcnt lgkmcnt(1)
    v_mfma_f32_16x16x32_bf16 v[84:87], a[56:59], v[76:79], v[84:87]
    v_mfma_f32_16x16x32_bf16 v[88:91], a[120:123], v[76:79], v[88:91]
    v_mfma_f32_16x16x32_bf16 v[92:95], a[184:187], v[76:79], v[92:95]
    v_mfma_f32_16x16x32_bf16 v[96:99], a[248:251], v[76:79], v[96:99]
    v_mfma_f32_16x16x32_bf16 v[100:103], v[76:79], v[184:187], v[100:103]
    v_mfma_f32_16x16x32_bf16 v[104:107], v[76:79], v[248:251], v[104:107]
    s_waitcnt lgkmcnt(0)
    v_mfma_f32_16x16x32_bf16 v[84:87], a[60:63], v[80:83], v[84:87]
    v_mfma_f32_16x16x32_bf16 v[88:91], a[124:127], v[80:83], v[88:91]
    v_mfma_f32_16x16x32_bf16 v[92:95], a[188:191], v[80:83], v[92:95]
    v_mfma_f32_16x16x32_bf16 v[96:99], a[252:255], v[80:83], v[96:99]
    v_mfma_f32_16x16x32_bf16 v[100:103], v[80:83], v[188:191], v[100:103]
    v_mfma_f32_16x16x32_bf16 v[104:107], v[80:83], v[252:255], v[104:107]
    s_nop 7
    s_nop 3
    ds_read_b128 v[20:23], v6 offset:0
    ds_read_b128 v[24:27], v6 offset:1024
    ds_read_b128 v[28:31], v6 offset:2048
    ds_read_b128 v[32:35], v6 offset:3072
    ds_read_b128 v[36:39], v6 offset:4096
    ds_read_b128 v[40:43], v6 offset:5120
    ds_read_b128 v[44:47], v6 offset:6144
    ds_read_b128 v[48:51], v6 offset:7168
    ds_read_b128 v[52:55], v6 offset:8192
    ds_read_b128 v[56:59], v6 offset:9216
    ds_read_b128 v[60:63], v6 offset:10240
    ds_read_b128 v[64:67], v6 offset:11264
    ds_read_b128 v[68:71], v6 offset:12288
    ds_read_b128 v[72:75], v6 offset:13312
    ds_read_b128 v[76:79], v6 offset:14336
    ds_read_b128 v[80:83], v6 offset:15360
    s_lshl_b32 s4, s16, 16
    s_add_u32 s5, s4, 0x4c00000
    s_add_u32 s4, s4, 0x4800000
    v_cvt_pk_bf16_f32 v84, v84, v85
    v_cvt_pk_bf16_f32 v85, v86, v87
    v_cvt_pk_bf16_f32 v88, v88, v89
    v_cvt_pk_bf16_f32 v89, v90, v91
    v_cvt_pk_bf16_f32 v92, v92, v93
    v_cvt_pk_bf16_f32 v93, v94, v95
    v_cvt_pk_bf16_f32 v96, v96, v97
    v_cvt_pk_bf16_f32 v97, v98, v99
    v_cvt_pk_bf16_f32 v100, v100, v101
    v_cvt_pk_bf16_f32 v101, v102, v103
    v_cvt_pk_bf16_f32 v104, v104, v105
    v_cvt_pk_bf16_f32 v105, v106, v107
    s_mov_b64 exec, s[30:31]
    ds_write_b64 v11, v[84:85] offset:8320
    ds_write_b64 v11, v[88:89] offset:8352
    ds_write_b64 v11, v[92:93] offset:10496
    s_cmp_lg_u32 s16, 99
    s_cbranch_scc0 KS_3
    buffer_store_dwordx2 v[92:93], v13, s[12:15], s4 offen offset:0
KS_3:
    ds_write_b64 v11, v[96:97] offset:10528
    s_cmp_lg_u32 s16, 99
    s_cbranch_scc0 KS_4
    buffer_store_dwordx2 v[96:97], v13, s[12:15], s4 offen offset:32
KS_4:
    s_mov_b64 exec, s[32:33]
    ds_write_b64 v12, v[100:101] offset:0
    s_cmp_lg_u32 s16, 99
    s_cbranch_scc0 KS_5
    buffer_store_dwordx2 v[100:101], v14, s[12:15], s5 offen offset:0
KS_5:
    ds_write_b64 v12, v[104:105] offset:256
    s_cmp_lg_u32 s16, 99
    s_cbranch_scc0 KS_6
    buffer_store_dwordx2 v[104:105], v14, s[12:15], s5 offen offset:256
KS_6:
    s_mov_b64 exec, -1
    s_waitcnt lgkmcnt(0)
    s_barrier
    s_cmp_eq_u32 s16, 63
    s_cbranch_scc1 rec_fin
    ds_read_b128 v[96:99], v8 offset:8320
    ds_read_b128 v[112:115], v8 offset:10496
    ds_read_b128 v[100:103], v8 offset:8384
    ds_read_b128 v[116:119], v8 offset:10560
    ds_read_b128 v[104:107], v8 offset:8448
    ds_read_b128 v[120:123], v8 offset:10624
    ds_read_b128 v[108:111], v8 offset:8512
    ds_read_b128 v[124:127], v8 offset:10688
    s_waitcnt lgkmcnt(6)
    v_mfma_f32_16x16x32_bf16 v[84:87], v[20:23], v[96:99], 0
    v_mfma_f32_16x16x32_bf16 v[88:91], v[36:39], v[96:99], 0
    v_mfma_f32_16x16x32_bf16 v[92:95], v[112:115], v[96:99], 0
    s_waitcnt lgkmcnt(4)
    v_mfma_f32_16x16x32_bf16 v[84:87], v[24:27], v[100:103], v[84:87]
    v_mfma_f32_16x16x32_bf16 v[88:91], v[40:43], v[100:103], v[88:91]
    v_mfma_f32_16x16x32_bf16 v[92:95], v[116:119], v[100:103], v[92:95]
    s_waitcnt lgkmcnt(2)
    v_mfma_f32_16x16x32_bf16 v[84:87], v[28:31], v[104:107], v[84:87]
    v_mfma_f32_16x16x32_bf16 v[88:91], v[44:47], v[104:107], v[88:91]
    v_mfma_f32_16x16x32_bf16 v[92:95], v[120:123], v[104:107], v[92:95]
    s_waitcnt lgkmcnt(0)
    v_mfma_f32_16x16x32_bf16 v[84:87], v[32:35], v[108:111], v[84:87]
    v_mfma_f32_16x16x32_bf16 v[88:91], v[48:51], v[108:111], v[88:91]
    v_mfma_f32_16x16x32_bf16 v[92:95], v[124:127], v[108:111], v[92:95]
    s_nop 7
    s_nop 3
    v_cvt_pk_bf16_f32 v104, v84, v85
    v_lshlrev_b32 v84, 16, v104
    v_and_b32 v85, 0xffff0000, v104
    v_mul_f32 v84, 0x3db504f3, v84
    v_mul_f32 v85, 0x3db504f3, v85
    v_cvt_pk_bf16_f32 v104, v86, v87
    v_lshlrev_b32 v86, 16, v104
    v_and_b32 v87, 0xffff0000, v104
    v_mul_f32 v86, 0x3db504f3, v86
    v_mul_f32 v87, 0x3db504f3, v87
    v_cvt_pk_bf16_f32 v104, v88, v89
    v_lshlrev_b32 v88, 16, v104
    v_and_b32 v89, 0xffff0000, v104
    v_mul_f32 v88, 0x3db504f3, v88
    v_mul_f32 v89, 0x3db504f3, v89
    v_cvt_pk_bf16_f32 v104, v90, v91
    v_lshlrev_b32 v90, 16, v104
    v_and_b32 v91, 0xffff0000, v104
    v_mul_f32 v90, 0x3db504f3, v90
    v_mul_f32 v91, 0x3db504f3, v91
    v_cvt_pk_bf16_f32 v104, v92, v93
    v_lshlrev_b32 v92, 16, v104
    v_and_b32 v93, 0xffff0000, v104
    v_mul_f32 v92, 0x3db504f3, v92
    v_mul_f32 v93, 0x3db504f3, v93
    v_cvt_pk_bf16_f32 v104, v94, v95
    v_lshlrev_b32 v94, 16, v104
    v_and_b32 v95, 0xffff0000, v104
    v_mul_f32 v94, 0x3db504f3, v94
    v_mul_f32 v95, 0x3db504f3, v95
    v_cvt_pk_bf16_f32 v104, v84, v85
    v_lshlrev_b32 v84, 16, v104
    v_and_b32 v85, 0xffff0000, v104
    v_cvt_pk_bf16_f32 v104, v86, v87
    v_lshlrev_b32 v86, 16, v104
    v_and_b32 v87, 0xffff0000, v104
    v_cvt_pk_bf16_f32 v104, v88, v89
    v_lshlrev_b32 v88, 16, v104
    v_and_b32 v89, 0xffff0000, v104
    v_cvt_pk_bf16_f32 v104, v90, v91
    v_lshlrev_b32 v90, 16, v104
    v_and_b32 v91, 0xffff0000, v104
    v_cvt_pk_bf16_f32 v104, v92, v93
    v_lshlrev_b32 v92, 16, v104
    v_and_b32 v93, 0xffff0000, v104
    v_cvt_pk_bf16_f32 v104, v94, v95
    v_lshlrev_b32 v94, 16, v104
    v_and_b32 v95, 0xffff0000, v104
    v_mov_b32 v107, 0xce6e6b28
    v_cmp_gt_u32 vcc, 2, v2
    s_nop 1
    v_cndmask_b32 v92, v107, v92, vcc
    v_cndmask_b32 v93, v107, v93, vcc
    v_cndmask_b32 v94, v107, v94, vcc
    v_cndmask_b32 v95, v107, v95, vcc
    v_max3_f32 v105, v84, v85, v86
    v_max3_f32 v105, v105, v87, v88
    v_max3_f32 v105, v105, v89, v90
    v_max3_f32 v105, v105, v91, v92
    v_max3_f32 v105, v105, v93, v94
    v_max_f32 v105, v105, v95
    v_mov_b32 v104, v105
    v_mov_b32 v106, v105
    s_nop 1
    v_permlane16_swap_b32 v104, v106
    s_nop 1
    v_max_f32 v105, v104, v106
    v_mov_b32 v104, v105
    v_mov_b32 v106, v105
    s_nop 1
    v_permlane32_swap_b32 v104, v106
    s_nop 1
    v_max_f32 v105, v104, v106
    v_mul_f32 v105, 0xbfb8aa3b, v105
    v_mov_b32 v107, 0x3fb8aa3b
    v_fma_f32 v84, v84, v107, v105
    v_exp_f32 v84, v84
    v_fma_f32 v85, v85, v107, v105
    v_exp_f32 v85, v85
    v_fma_f32 v86, v86, v107, v105
    v_exp_f32 v86, v86
    v_fma_f32 v87, v87, v107, v105
    v_exp_f32 v87, v87
    v_fma_f32 v88, v88, v107, v105
    v_exp_f32 v88, v88
    v_fma_f32 v89, v89, v107, v105
    v_exp_f32 v89, v89
    v_fma_f32 v90, v90, v107, v105
    v_exp_f32 v90, v90
    v_fma_f32 v91, v91, v107, v105
    v_exp_f32 v91, v91
    v_fma_f32 v92, v92, v107, v105
    v_exp_f32 v92, v92
    v_fma_f32 v93, v93, v107, v105
    v_exp_f32 v93, v93
    v_fma_f32 v94, v94, v107, v105
    v_exp_f32 v94, v94
    v_fma_f32 v95, v95, v107, v105
    v_exp_f32 v95, v95
    s_nop 1
    v_add_f32 v106, v84, v85
    v_add_f32 v106, v106, v86
    v_add_f32 v106, v106, v87
    v_add_f32 v106, v106, v88
    v_add_f32 v106, v106, v89
    v_add_f32 v106, v106, v90
    v_add_f32 v106, v106, v91
    v_add_f32 v106, v106, v92
    v_add_f32 v106, v106, v93
    v_add_f32 v106, v106, v94
    v_add_f32 v106, v106, v95
    v_mov_b32 v104, v106
    v_mov_b32 v105, v106
    s_nop 1
    v_permlane16_swap_b32 v104, v105
    s_nop 1
    v_add_f32 v106, v104, v105
    v_mov_b32 v104, v106
    v_mov_b32 v105, v106
    s_nop 1
    v_permlane32_swap_b32 v104, v105
    s_nop 1
    v_add_f32 v106, v104, v105
    v_rcp_f32 v106, v106
    s_nop 1
    v_mul_f32 v84, v84, v106
    v_mul_f32 v85, v85, v106
    v_mul_f32 v86, v86, v106
    v_mul_f32 v87, v87, v106
    v_mul_f32 v88, v88, v106
    v_mul_f32 v89, v89, v106
    v_mul_f32 v90, v90, v106
    v_mul_f32 v91, v91, v106
    v_mul_f32 v92, v92, v106
    v_mul_f32 v93, v93, v106
    v_mul_f32 v94, v94, v106
    v_mul_f32 v95, v95, v106
    v_cvt_pk_bf16_f32 v96, v84, v85
    v_cvt_pk_bf16_f32 v97, v86, v87
    v_cvt_pk_bf16_f32 v98, v88, v89
    v_cvt_pk_bf16_f32 v99, v90, v91
    v_cvt_pk_bf16_f32 v100, v92, v93
    v_cvt_pk_bf16_f32 v101, v94, v95
    v_mov_b32 v102, 0
    v_mov_b32 v103, 0
    s_nop 1
    v_mov_b32 v108, 0
    v_mov_b32 v109, 0
    v_mov_b32 v110, 0
    v_mov_b32 v111, 0
    v_mov_b32 v112, 0
    v_mov_b32 v113, 0
    v_mov_b32 v114, 0
    v_mov_b32 v115, 0
    v_mov_b32 v116, 0
    v_mov_b32 v117, 0
    v_mov_b32 v118, 0
    v_mov_b32 v119, 0
    v_mov_b32 v120, 0
    v_mov_b32 v121, 0
    v_mov_b32 v122, 0
    v_mov_b32 v123, 0
    v_mov_b32 v124, 0
    v_mov_b32 v125, 0
    v_mov_b32 v126, 0
    v_mov_b32 v127, 0
    s_mov_b64 exec, s[32:33]
    ds_read_b64 v[108:109], v9 offset:0
    ds_read_b64 v[112:113], v9 offset:256
    ds_read_b64 v[116:117], v9 offset:512
    ds_read_b64 v[120:121], v9 offset:768
    ds_read_b64 v[124:125], v9 offset:1024
    s_mov_b64 exec, -1
    v_mfma_f32_16x16x32_bf16 v[20:23], v[52:55], v[96:99], 0
    v_mfma_f32_16x16x32_bf16 v[24:27], v[56:59], v[96:99], 0
    v_mfma_f32_16x16x32_bf16 v[28:31], v[60:63], v[96:99], 0
    v_mfma_f32_16x16x32_bf16 v[32:35], v[64:67], v[96:99], 0
    v_mfma_f32_16x16x32_bf16 v[36:39], v[68:71], v[96:99], 0
    v_mfma_f32_16x16x32_bf16 v[40:43], v[72:75], v[96:99], 0
    v_mfma_f32_16x16x32_bf16 v[44:47], v[76:79], v[96:99], 0
    v_mfma_f32_16x16x32_bf16 v[48:51], v[80:83], v[96:99], 0
    s_waitcnt lgkmcnt(0)
    v_mfma_f32_16x16x32_bf16 v[20:23], v[108:111], v[100:103], v[20:23]
    v_mfma_f32_16x16x32_bf16 v[24:27], v[112:115], v[100:103], v[24:27]
    v_mfma_f32_16x16x32_bf16 v[28:31], v[116:119], v[100:103], v[28:31]
    v_mfma_f32_16x16x32_bf16 v[32:35], v[120:123], v[100:103], v[32:35]
    v_mfma_f32_16x16x32_bf16 v[36:39], v[124:127], v[100:103], v[36:39]
    s_mov_b64 exec, s[32:33]
    ds_read_b64 v[108:109], v9 offset:1280
    ds_read_b64 v[112:113], v9 offset:1536
    ds_read_b64 v[116:117], v9 offset:1792
    s_mov_b64 exec, -1
    s_waitcnt lgkmcnt(0)
    v_mfma_f32_16x16x32_bf16 v[40:43], v[108:111], v[100:103], v[40:43]
    v_mfma_f32_16x16x32_bf16 v[44:47], v[112:115], v[100:103], v[44:47]
    v_mfma_f32_16x16x32_bf16 v[48:51], v[116:119], v[100:103], v[48:51]
    s_lshl_b32 s4, s3, 15
    s_add_u32 s4, s4, 31104
    v_add_u32 v7, s4, v4
    ds_read_b128 v[52:55], v7 offset:0
    ds_read_b128 v[56:59], v7 offset:1024
    ds_read_b128 v[60:63], v7 offset:2048
    ds_read_b128 v[64:67], v7 offset:3072
    ds_read_b128 v[68:71], v7 offset:4096
    ds_read_b128 v[72:75], v7 offset:5120
    ds_read_b128 v[76:79], v7 offset:6144
    ds_read_b128 v[80:83], v7 offset:7168
    s_nop 7
    s_nop 3
    v_cvt_pk_bf16_f32 v84, v20, v21
    v_cvt_pk_bf16_f32 v85, v22, v23
    v_cvt_pk_bf16_f32 v86, v24, v25
    v_cvt_pk_bf16_f32 v87, v26, v27
    v_cvt_pk_bf16_f32 v88, v28, v29
    v_cvt_pk_bf16_f32 v89, v30, v31
    v_cvt_pk_bf16_f32 v90, v32, v33
    v_cvt_pk_bf16_f32 v91, v34, v35
    v_cvt_pk_bf16_f32 v92, v36, v37
    v_cvt_pk_bf16_f32 v93, v38, v39
    v_cvt_pk_bf16_f32 v94, v40, v41
    v_cvt_pk_bf16_f32 v95, v42, v43
    v_cvt_pk_bf16_f32 v96, v44, v45
    v_cvt_pk_bf16_f32 v97, v46, v47
    v_cvt_pk_bf16_f32 v98, v48, v49
    v_cvt_pk_bf16_f32 v99, v50, v51
    s_nop 1
    ds_read_b128 v[100:103], v7 offset:8192
    ds_read_b128 v[104:107], v7 offset:9216
    ds_read_b128 v[108:111], v7 offset:10240
    ds_read_b128 v[112:115], v7 offset:11264
    s_waitcnt lgkmcnt(8)
    v_mfma_f32_16x16x32_bf16 v[20:23], v[84:87], v[52:55], 0
    v_mfma_f32_16x16x32_bf16 v[20:23], v[88:91], v[56:59], v[20:23]
    v_mfma_f32_16x16x32_bf16 v[20:23], v[92:95], v[60:63], v[20:23]
    v_mfma_f32_16x16x32_bf16 v[20:23], v[96:99], v[64:67], v[20:23]
    ds_read_b128 v[52:55], v7 offset:12288
    ds_read_b128 v[56:59], v7 offset:13312
    ds_read_b128 v[60:63], v7 offset:14336
    ds_read_b128 v[64:67], v7 offset:15360
    s_waitcnt lgkmcnt(8)
    v_mfma_f32_16x16x32_bf16 v[24:27], v[84:87], v[68:71], 0
    v_mfma_f32_16x16x32_bf16 v[24:27], v[88:91], v[72:75], v[24:27]
    v_mfma_f32_16x16x32_bf16 v[24:27], v[92:95], v[76:79], v[24:27]
    v_mfma_f32_16x16x32_bf16 v[24:27], v[96:99], v[80:83], v[24:27]
    ds_read_b128 v[68:71], v7 offset:16384
    ds_read_b128 v[72:75], v7 offset:17408
    ds_read_b128 v[76:79], v7 offset:18432
    ds_read_b128 v[80:83], v7 offset:19456
    s_waitcnt lgkmcnt(8)
    v_mfma_f32_16x16x32_bf16 v[28:31], v[84:87], v[100:103], 0
    v_mfma_f32_16x16x32_bf16 v[28:31], v[88:91], v[104:107], v[28:31]
    v_mfma_f32_16x16x32_bf16 v[28:31], v[92:95], v[108:111], v[28:31]
    v_mfma_f32_16x16x32_bf16 v[28:31], v[96:99], v[112:115], v[28:31]
    ds_read_b128 v[100:103], v7 offset:20480
    ds_read_b128 v[104:107], v7 offset:21504
    ds_read_b128 v[108:111], v7 offset:22528
    ds_read_b128 v[112:115], v7 offset:23552
    s_waitcnt lgkmcnt(8)
    v_mfma_f32_16x16x32_bf16 v[32:35], v[84:87], v[52:55], 0
    v_mfma_f32_16x16x32_bf16 v[32:35], v[88:91], v[56:59], v[32:35]
    v_mfma_f32_16x16x32_bf16 v[32:35], v[92:95], v[60:63], v[32:35]
    v_mfma_f32_16x16x32_bf16 v[32:35], v[96:99], v[64:67], v[32:35]
    ds_read_b128 v[52:55], v7 offset:24576
    ds_read_b128 v[56:59], v7 offset:25600
    ds_read_b128 v[60:63], v7 offset:26624
    ds_read_b128 v[64:67], v7 offset:27648
    s_waitcnt lgkmcnt(8)
    v_mfma_f32_16x16x32_bf16 v[36:39], v[84:87], v[68:71], 0
    v_mfma_f32_16x16x32_bf16 v[36:39], v[88:91], v[72:75], v[36:39]
    v_mfma_f32_16x16x32_bf16 v[36:39], v[92:95], v[76:79], v[36:39]
    v_mfma_f32_16x16x32_bf16 v[36:39], v[96:99], v[80:83], v[36:39]
    ds_read_b128 v[68:71], v7 offset:28672
    ds_read_b128 v[72:75], v7 offset:29696
    ds_read_b128 v[76:79], v7 offset:30720
    ds_read_b128 v[80:83], v7 offset:31744
    s_waitcnt lgkmcnt(8)
    v_mfma_f32_16x16x32_bf16 v[40:43], v[84:87], v[100:103], 0
    v_mfma_f32_16x16x32_bf16 v[40:43], v[88:91], v[104:107], v[40:43]
    v_mfma_f32_16x16x32_bf16 v[40:43], v[92:95], v[108:111], v[40:43]
    v_mfma_f32_16x16x32_bf16 v[40:43], v[96:99], v[112:115], v[40:43]
    s_waitcnt lgkmcnt(4)
    v_mfma_f32_16x16x32_bf16 v[44:47], v[84:87], v[52:55], 0
    v_mfma_f32_16x16x32_bf16 v[44:47], v[88:91], v[56:59], v[44:47]
    v_mfma_f32_16x16x32_bf16 v[44:47], v[92:95], v[60:63], v[44:47]
    v_mfma_f32_16x16x32_bf16 v[44:47], v[96:99], v[64:67], v[44:47]
    s_waitcnt lgkmcnt(0)
    v_mfma_f32_16x16x32_bf16 v[48:51], v[84:87], v[68:71], 0
    v_mfma_f32_16x16x32_bf16 v[48:51], v[88:91], v[72:75], v[48:51]
    v_mfma_f32_16x16x32_bf16 v[48:51], v[92:95], v[76:79], v[48:51]
    v_mfma_f32_16x16x32_bf16 v[48:51], v[96:99], v[80:83], v[48:51]
    s_nop 7
    s_nop 3
    s_add_u32 s17, s16, 1
    s_mov_b32 s18, 0x8000000
    s_mov_b32 s19, 0xffffff80
    v_permlane32_swap_b32 v20, v22
    v_permlane32_swap_b32 v21, v23
    v_mov_b32 v100, s17
    v_and_or_b32 v52, v20, s19, v100
    v_and_or_b32 v53, v21, s19, v100
    v_permlane32_swap_b32 v24, v26
    v_permlane32_swap_b32 v25, v27
    v_mov_b32 v100, s17
    v_and_or_b32 v54, v24, s19, v100
    v_and_or_b32 v55, v25, s19, v100
    v_permlane32_swap_b32 v28, v30
    v_permlane32_swap_b32 v29, v31
    v_mov_b32 v100, s17
    v_and_or_b32 v56, v28, s19, v100
    v_and_or_b32 v57, v29, s19, v100
    v_permlane32_swap_b32 v32, v34
    v_permlane32_swap_b32 v33, v35
    v_mov_b32 v100, s17
    v_and_or_b32 v58, v32, s19, v100
    v_and_or_b32 v59, v33, s19, v100
    v_permlane32_swap_b32 v36, v38
    v_permlane32_swap_b32 v37, v39
    v_mov_b32 v100, s17
    v_and_or_b32 v60, v36, s19, v100
    v_and_or_b32 v61, v37, s19, v100
    v_permlane32_swap_b32 v40, v42
    v_permlane32_swap_b32 v41, v43
    v_mov_b32 v100, s17
    v_and_or_b32 v62, v40, s19, v100
    v_and_or_b32 v63, v41, s19, v100
    v_permlane32_swap_b32 v44, v46
    v_permlane32_swap_b32 v45, v47
    v_mov_b32 v100, s17
    v_and_or_b32 v64, v44, s19, v100
    v_and_or_b32 v65, v45, s19, v100
    v_permlane32_swap_b32 v48, v50
    v_permlane32_swap_b32 v49, v51
    v_mov_b32 v100, s17
    v_and_or_b32 v66, v48, s19, v100
    v_and_or_b32 v67, v49, s19, v100
    s_cmp_eq_u32 s44, 1
    s_cbranch_scc1 R_pubL
    buffer_store_dwordx4 v[52:55], v15, s[12:15], s18 offen sc1
    s_add_u32 s18, s18, 32768
    buffer_store_dwordx4 v[56:59], v15, s[12:15], s18 offen sc1
    s_add_u32 s18, s18, 32768
    buffer_store_dwordx4 v[60:63], v15, s[12:15], s18 offen sc1
    s_add_u32 s18, s18, 32768
    buffer_store_dwordx4 v[64:67], v15, s[12:15], s18 offen sc1
    s_add_u32 s18, s18, 32768
    s_branch R_pubD
R_pubL:
    buffer_store_dwordx4 v[52:55], v15, s[12:15], s18 offen
    s_add_u32 s18, s18, 32768
    buffer_store_dwordx4 v[56:59], v15, s[12:15], s18 offen
    s_add_u32 s18, s18, 32768
    buffer_store_dwordx4 v[60:63], v15, s[12:15], s18 offen
    s_add_u32 s18, s18, 32768
    buffer_store_dwordx4 v[64:67], v15, s[12:15], s18 offen
    s_add_u32 s18, s18, 32768
R_pubD:
    s_waitcnt vmcnt(0)
    s_mov_b32 s19, 0
    s_mov_b32 s18, 0x8000000
    s_add_u32 s22, s18, 4096
R_p1loop:
    buffer_load_dwordx2 v[20:21], v16, s[12:15], s18 offen offset:0 sc1
    buffer_load_dwordx2 v[22:23], v16, s[12:15], s18 offen offset:1024 sc1
    buffer_load_dwordx2 v[24:25], v16, s[12:15], s18 offen offset:2048 sc1
    buffer_load_dwordx2 v[26:27], v16, s[12:15], s18 offen offset:3072 sc1
    buffer_load_dwordx2 v[28:29], v16, s[12:15], s22 offen offset:0 sc1
    buffer_load_dwordx2 v[30:31], v16, s[12:15], s22 offen offset:1024 sc1
    buffer_load_dwordx2 v[32:33], v16, s[12:15], s22 offen offset:2048 sc1
    buffer_load_dwordx2 v[34:35], v16, s[12:15], s22 offen offset:3072 sc1
    s_waitcnt vmcnt(0)
    v_xor_b32 v100, s17, v20
    v_xor_b32 v101, s17, v21
    v_or_b32 v100, v100, v101
    v_xor_b32 v101, s17, v22
    v_or_b32 v100, v100, v101
    v_xor_b32 v101, s17, v23
    v_or_b32 v100, v100, v101
    v_xor_b32 v101, s17, v24
    v_or_b32 v100, v100, v101
    v_xor_b32 v101, s17, v25
    v_or_b32 v100, v100, v101
    v_xor_b32 v101, s17, v26
    v_or_b32 v100, v100, v101
    v_xor_b32 v101, s17, v27
    v_or_b32 v100, v100, v101
    v_xor_b32 v101, s17, v28
    v_or_b32 v100, v100, v101
    v_xor_b32 v101, s17, v29
    v_or_b32 v100, v100, v101
    v_xor_b32 v101, s17, v30
    v_or_b32 v100, v100, v101
    v_xor_b32 v101, s17, v31
    v_or_b32 v100, v100, v101
    v_xor_b32 v101, s17, v32
    v_or_b32 v100, v100, v101
    v_xor_b32 v101, s17, v33
    v_or_b32 v100, v100, v101
    v_xor_b32 v101, s17, v34
    v_or_b32 v100, v100, v101
    v_xor_b32 v101, s17, v35
    v_or_b32 v100, v100, v101
    v_and_b32 v100, 0x7f, v100
    v_cmp_ne_u32 vcc, 0, v100
    s_add_u32 s19, s19, 1
    s_cmp_ge_u32 s19, 32768
    s_cbranch_scc1 R_p1done
    s_cbranch_vccnz R_p1loop
R_p1done:
    s_and_b32 s4, s17, 3
    s_cmp_lg_u32 s4, 0
    s_cbranch_scc1 KF_8
    s_lshr_b32 s4, s17, 2
    s_lshl_b32 s4, s4, 6
    s_add_u32 s4, s4, s2
    s_lshl_b32 s4, s4, 2
    s_add_u32 s4, s4, 0x8104000
    s_mov_b32 s5, 0
    v_mov_b32 v116, 0
KF_7:
    buffer_load_dword v117, v116, s[12:15], s4 offen sc1
    buffer_load_dword v118, v116, s[12:15], s4 offen offset:128 sc1
    s_waitcnt vmcnt(0)
    v_and_b32 v117, v117, v118
    s_nop 0
    v_readfirstlane_b32 s6, v117
    s_add_u32 s5, s5, 1
    s_cmp_ge_u32 s5, 0x40000
    s_cbranch_scc1 KF_8
    s_cmp_eq_u32 s6, 0
    s_cbranch_scc1 KF_7
KF_8:
    s_mov_b32 m0, s34
    s_nop 0
    buffer_load_dwordx4 v4, s[12:15], s35 offen offset:0 sc1 lds
    buffer_load_dwordx4 v4, s[12:15], s35 offen offset:1024 sc1 lds
    buffer_load_dwordx4 v4, s[12:15], s35 offen offset:2048 sc1 lds
    buffer_load_dwordx4 v4, s[12:15], s35 offen offset:3072 sc1 lds
    s_add_u32 s35, s35, 0x80000
    v_add_f32 v84, v20, v22
    v_add_f32 v85, v21, v23
    v_add_f32 v84, v84, v24
    v_add_f32 v85, v85, v25
    v_add_f32 v84, v84, v26
    v_add_f32 v85, v85, v27
    v_add_f32 v84, v84, v28
    v_add_f32 v85, v85, v29
    v_add_f32 v84, v84, v30
    v_add_f32 v85, v85, v31
    v_add_f32 v84, v84, v32
    v_add_f32 v85, v85, v33
    v_add_f32 v84, v84, v34
    v_add_f32 v85, v85, v35
    v_mov_b32 v86, v84
    v_mov_b32 v87, v84
    s_nop 1
    v_permlane16_swap_b32 v86, v87
    s_nop 1
    v_add_f32 v84, v86, v87
    v_mov_b32 v86, v84
    v_mov_b32 v87, v84
    s_nop 1
    v_permlane32_swap_b32 v86, v87
    s_nop 1
    v_add_f32 v84, v86, v87
    v_mov_b32 v86, v85
    v_mov_b32 v87, v85
    s_nop 1
    v_permlane16_swap_b32 v86, v87
    s_nop 1
    v_add_f32 v85, v86, v87
    v_mov_b32 v86, v85
    v_mov_b32 v87, v85
    s_nop 1
    v_permlane32_swap_b32 v86, v87
    s_nop 1
    v_add_f32 v85, v86, v87
    v_cvt_pk_bf16_f32 v88, v84, v85
    v_mov_b32 v89, s17
    v_lshlrev_b32 v86, 3, v3
    s_lshl_b32 s4, s2, 9
    s_lshl_b32 s5, s3, 7
    s_add_u32 s4, s4, s5
    s_add_u32 s4, s4, 0x8100000
    s_mov_b64 exec, 0xffff
    s_cmp_eq_u32 s44, 1
    s_cbranch_scc1 R_st2l
    buffer_store_dwordx2 v[88:89], v86, s[12:15], s4 offen sc1
    s_branch R_st2d
    R_st2l:
    buffer_store_dwordx2 v[88:89], v86, s[12:15], s4 offen
    R_st2d:
    s_mov_b64 exec, -1
R_next:
    s_add_u32 s16, s16, 1
    s_branch R_loop
rec_fin:
rec_end:
    s_endpgm
qkv_kernel_entry:
    s_sub_u32 s2, s2, 256
    s_cmp_ge_u32 s2, 1024
    s_cbranch_scc1 QE_q
    s_lshr_b32 s4, s2, 6
    s_and_b32 s5, s2, 63
    s_add_u32 s5, s5, 32
    s_branch QE_d
    QE_q:
    s_sub_u32 s5, s2, 1024
    s_lshr_b32 s4, s5, 5
    s_and_b32 s5, s5, 31
    QE_d:
    s_cmp_ge_u32 s2, 1536
    s_cbranch_scc1 qkv_kernel_end
    s_lshl_b32 s2, s5, 4
    s_add_u32 s2, s2, s4
    s_load_dwordx2 s[38:39], s[0:1], 104
    s_load_dwordx2 s[36:37], s[0:1], 88
    s_cmp_ge_u32 s2, 1536
    s_cbranch_scc1 qkv_kernel_end
    v_and_b32 v1, 63, v0
    v_lshrrev_b32 v2, 4, v1
    v_and_b32 v3, 15, v1
    v_lshrrev_b32 v4, 6, v0
    s_nop 0
    v_readfirstlane_b32 s3, v4
    s_waitcnt lgkmcnt(0)
    s_mov_b32 s12, s38
    s_mov_b32 s13, s39
    s_mov_b32 s14, 0x10000000
    s_mov_b32 s15, 0x20000
    s_lshr_b32 s4, s3, 1
    s_and_b32 s5, s3, 1
    s_and_b32 s8, s2, 15
    s_lshr_b32 s9, s2, 4
    s_lshr_b32 s10, s9, 5
    s_lshl_b32 s16, s8, 17
    s_add_u32 s16, s16, 0x0
    s_lshl_b32 s17, s9, 17
    s_add_u32 s17, s17, 0x200000
    s_mov_b32 s21, 16384
    s_mov_b32 s23, 16384
    s_cmp_lt_u32 s10, 2
    s_cselect_b32 s20, s17, s16
    s_cselect_b32 s22, s16, s17
    s_and_b32 s11, s9, 31
    v_lshlrev_b32 v4, 4, v1
    s_mul_i32 s6, s4, 4
    s_mul_i32 s6, s6, s21
    s_add_u32 s6, s6, s20
    s_mul_i32 s7, s5, 4
    s_mul_i32 s7, s7, s23
    s_add_u32 s7, s7, s22
    v_add_u32 v8, s6, v4
    s_add_u32 s6, s6, s21
    v_add_u32 v9, s6, v4
    s_add_u32 s6, s6, s21
    v_add_u32 v10, s6, v4
    s_add_u32 s6, s6, s21
    v_add_u32 v11, s6, v4
    s_add_u32 s6, s6, s21
    v_add_u32 v12, s7, v4
    s_add_u32 s7, s7, s23
    v_add_u32 v13, s7, v4
    s_add_u32 s7, s7, s23
    v_add_u32 v14, s7, v4
    s_add_u32 s7, s7, s23
    v_add_u32 v15, s7, v4
    s_add_u32 s7, s7, s23
    v_mov_b32 v144, 0
    v_mov_b32 v145, 0
    v_mov_b32 v146, 0
    v_mov_b32 v147, 0
    v_mov_b32 v148, 0
    v_mov_b32 v149, 0
    v_mov_b32 v150, 0
    v_mov_b32 v151, 0
    v_mov_b32 v152, 0
    v_mov_b32 v153, 0
    v_mov_b32 v154, 0
    v_mov_b32 v155, 0
    v_mov_b32 v156, 0
    v_mov_b32 v157, 0
    v_mov_b32 v158, 0
    v_mov_b32 v159, 0
    v_mov_b32 v160, 0
    v_mov_b32 v161, 0
    v_mov_b32 v162, 0
    v_mov_b32 v163, 0
    v_mov_b32 v164, 0
    v_mov_b32 v165, 0
    v_mov_b32 v166, 0
    v_mov_b32 v167, 0
    v_mov_b32 v168, 0
    v_mov_b32 v169, 0
    v_mov_b32 v170, 0
    v_mov_b32 v171, 0
    v_mov_b32 v172, 0
    v_mov_b32 v173, 0
    v_mov_b32 v174, 0
    v_mov_b32 v175, 0
    v_mov_b32 v176, 0
    v_mov_b32 v177, 0
    v_mov_b32 v178, 0
    v_mov_b32 v179, 0
    v_mov_b32 v180, 0
    v_mov_b32 v181, 0
    v_mov_b32 v182, 0
    v_mov_b32 v183, 0
    v_mov_b32 v184, 0
    v_mov_b32 v185, 0
    v_mov_b32 v186, 0
    v_mov_b32 v187, 0
    v_mov_b32 v188, 0
    v_mov_b32 v189, 0
    v_mov_b32 v190, 0
    v_mov_b32 v191, 0
    v_mov_b32 v192, 0
    v_mov_b32 v193, 0
    v_mov_b32 v194, 0
    v_mov_b32 v195, 0
    v_mov_b32 v196, 0
    v_mov_b32 v197, 0
    v_mov_b32 v198, 0
    v_mov_b32 v199, 0
    v_mov_b32 v200, 0
    v_mov_b32 v201, 0
    v_mov_b32 v202, 0
    v_mov_b32 v203, 0
    v_mov_b32 v204, 0
    v_mov_b32 v205, 0
    v_mov_b32 v206, 0
    v_mov_b32 v207, 0
    s_mov_b32 s24, 0
    buffer_load_dwordx4 v[16:19], v8, s[12:15], s24 offen
    buffer_load_dwordx4 v[20:23], v9, s[12:15], s24 offen
    buffer_load_dwordx4 v[24:27], v10, s[12:15], s24 offen
    buffer_load_dwordx4 v[28:31], v11, s[12:15], s24 offen
    buffer_load_dwordx4 v[32:35], v12, s[12:15], s24 offen
    buffer_load_dwordx4 v[36:39], v13, s[12:15], s24 offen
    buffer_load_dwordx4 v[40:43], v14, s[12:15], s24 offen
    buffer_load_dwordx4 v[44:47], v15, s[12:15], s24 offen
    buffer_load_dwordx4 v[48:51], v8, s[12:15], s24 offen offset:1024
    buffer_load_dwordx4 v[52:55], v9, s[12:15], s24 offen offset:1024
    buffer_load_dwordx4 v[56:59], v10, s[12:15], s24 offen offset:1024
    buffer_load_dwordx4 v[60:63], v11, s[12:15], s24 offen offset:1024
    buffer_load_dwordx4 v[64:67], v12, s[12:15], s24 offen offset:1024
    buffer_load_dwordx4 v[68:71], v13, s[12:15], s24 offen offset:1024
    buffer_load_dwordx4 v[72:75], v14, s[12:15], s24 offen offset:1024
    buffer_load_dwordx4 v[76:79], v15, s[12:15], s24 offen offset:1024
    buffer_load_dwordx4 v[80:83], v8, s[12:15], s24 offen offset:2048
    buffer_load_dwordx4 v[84:87], v9, s[12:15], s24 offen offset:2048
    buffer_load_dwordx4 v[88:91], v10, s[12:15], s24 offen offset:2048
    buffer_load_dwordx4 v[92:95], v11, s[12:15], s24 offen offset:2048
    buffer_load_dwordx4 v[96:99], v12, s[12:15], s24 offen offset:2048
    buffer_load_dwordx4 v[100:103], v13, s[12:15], s24 offen offset:2048
    buffer_load_dwordx4 v[104:107], v14, s[12:15], s24 offen offset:2048
    buffer_load_dwordx4 v[108:111], v15, s[12:15], s24 offen offset:2048
qkv_kernel_loop:
    buffer_load_dwordx4 v[112:115], v8, s[12:15], s24 offen offset:3072
    buffer_load_dwordx4 v[116:119], v9, s[12:15], s24 offen offset:3072
    buffer_load_dwordx4 v[120:123], v10, s[12:15], s24 offen offset:3072
    buffer_load_dwordx4 v[124:127], v11, s[12:15], s24 offen offset:3072
    buffer_load_dwordx4 v[128:131], v12, s[12:15], s24 offen offset:3072
    buffer_load_dwordx4 v[132:135], v13, s[12:15], s24 offen offset:3072
    buffer_load_dwordx4 v[136:139], v14, s[12:15], s24 offen offset:3072
    buffer_load_dwordx4 v[140:143], v15, s[12:15], s24 offen offset:3072
    s_add_u32 s24, s24, 4096
    s_waitcnt vmcnt(24)
    v_mfma_f32_16x16x32_bf16 v[144:147], v[16:19], v[32:35], v[144:147]
    v_mfma_f32_16x16x32_bf16 v[148:151], v[16:19], v[36:39], v[148:151]
    v_mfma_f32_16x16x32_bf16 v[152:155], v[16:19], v[40:43], v[152:155]
    v_mfma_f32_16x16x32_bf16 v[156:159], v[16:19], v[44:47], v[156:159]
    v_mfma_f32_16x16x32_bf16 v[160:163], v[20:23], v[32:35], v[160:163]
    v_mfma_f32_16x16x32_bf16 v[164:167], v[20:23], v[36:39], v[164:167]
    v_mfma_f32_16x16x32_bf16 v[168:171], v[20:23], v[40:43], v[168:171]
    v_mfma_f32_16x16x32_bf16 v[172:175], v[20:23], v[44:47], v[172:175]
    v_mfma_f32_16x16x32_bf16 v[176:179], v[24:27], v[32:35], v[176:179]
    v_mfma_f32_16x16x32_bf16 v[180:183], v[24:27], v[36:39], v[180:183]
    v_mfma_f32_16x16x32_bf16 v[184:187], v[24:27], v[40:43], v[184:187]
    v_mfma_f32_16x16x32_bf16 v[188:191], v[24:27], v[44:47], v[188:191]
    v_mfma_f32_16x16x32_bf16 v[192:195], v[28:31], v[32:35], v[192:195]
    v_mfma_f32_16x16x32_bf16 v[196:199], v[28:31], v[36:39], v[196:199]
    v_mfma_f32_16x16x32_bf16 v[200:203], v[28:31], v[40:43], v[200:203]
    v_mfma_f32_16x16x32_bf16 v[204:207], v[28:31], v[44:47], v[204:207]
    buffer_load_dwordx4 v[16:19], v8, s[12:15], s24 offen
    buffer_load_dwordx4 v[20:23], v9, s[12:15], s24 offen
    buffer_load_dwordx4 v[24:27], v10, s[12:15], s24 offen
    buffer_load_dwordx4 v[28:31], v11, s[12:15], s24 offen
    buffer_load_dwordx4 v[32:35], v12, s[12:15], s24 offen
    buffer_load_dwordx4 v[36:39], v13, s[12:15], s24 offen
    buffer_load_dwordx4 v[40:43], v14, s[12:15], s24 offen
    buffer_load_dwordx4 v[44:47], v15, s[12:15], s24 offen
    s_waitcnt vmcnt(24)
    v_mfma_f32_16x16x32_bf16 v[144:147], v[48:51], v[64:67], v[144:147]
    v_mfma_f32_16x16x32_bf16 v[148:151], v[48:51], v[68:71], v[148:151]
    v_mfma_f32_16x16x32_bf16 v[152:155], v[48:51], v[72:75], v[152:155]
    v_mfma_f32_16x16x32_bf16 v[156:159], v[48:51], v[76:79], v[156:159]
    v_mfma_f32_16x16x32_bf16 v[160:163], v[52:55], v[64:67], v[160:163]
    v_mfma_f32_16x16x32_bf16 v[164:167], v[52:55], v[68:71], v[164:167]
    v_mfma_f32_16x16x32_bf16 v[168:171], v[52:55], v[72:75], v[168:171]
    v_mfma_f32_16x16x32_bf16 v[172:175], v[52:55], v[76:79], v[172:175]
    v_mfma_f32_16x16x32_bf16 v[176:179], v[56:59], v[64:67], v[176:179]
    v_mfma_f32_16x16x32_bf16 v[180:183], v[56:59], v[68:71], v[180:183]
    v_mfma_f32_16x16x32_bf16 v[184:187], v[56:59], v[72:75], v[184:187]
    v_mfma_f32_16x16x32_bf16 v[188:191], v[56:59], v[76:79], v[188:191]
    v_mfma_f32_16x16x32_bf16 v[192:195], v[60:63], v[64:67], v[192:195]
    v_mfma_f32_16x16x32_bf16 v[196:199], v[60:63], v[68:71], v[196:199]
    v_mfma_f32_16x16x32_bf16 v[200:203], v[60:63], v[72:75], v[200:203]
    v_mfma_f32_16x16x32_bf16 v[204:207], v[60:63], v[76:79], v[204:207]
    buffer_load_dwordx4 v[48:51], v8, s[12:15], s24 offen offset:1024
    buffer_load_dwordx4 v[52:55], v9, s[12:15], s24 offen offset:1024
    buffer_load_dwordx4 v[56:59], v10, s[12:15], s24 offen offset:1024
    buffer_load_dwordx4 v[60:63], v11, s[12:15], s24 offen offset:1024
    buffer_load_dwordx4 v[64:67], v12, s[12:15], s24 offen offset:1024
    buffer_load_dwordx4 v[68:71], v13, s[12:15], s24 offen offset:1024
    buffer_load_dwordx4 v[72:75], v14, s[12:15], s24 offen offset:1024
    buffer_load_dwordx4 v[76:79], v15, s[12:15], s24 offen offset:1024
    s_waitcnt vmcnt(24)
    v_mfma_f32_16x16x32_bf16 v[144:147], v[80:83], v[96:99], v[144:147]
    v_mfma_f32_16x16x32_bf16 v[148:151], v[80:83], v[100:103], v[148:151]
    v_mfma_f32_16x16x32_bf16 v[152:155], v[80:83], v[104:107], v[152:155]
    v_mfma_f32_16x16x32_bf16 v[156:159], v[80:83], v[108:111], v[156:159]
    v_mfma_f32_16x16x32_bf16 v[160:163], v[84:87], v[96:99], v[160:163]
    v_mfma_f32_16x16x32_bf16 v[164:167], v[84:87], v[100:103], v[164:167]
    v_mfma_f32_16x16x32_bf16 v[168:171], v[84:87], v[104:107], v[168:171]
    v_mfma_f32_16x16x32_bf16 v[172:175], v[84:87], v[108:111], v[172:175]
    v_mfma_f32_16x16x32_bf16 v[176:179], v[88:91], v[96:99], v[176:179]
    v_mfma_f32_16x16x32_bf16 v[180:183], v[88:91], v[100:103], v[180:183]
    v_mfma_f32_16x16x32_bf16 v[184:187], v[88:91], v[104:107], v[184:187]
    v_mfma_f32_16x16x32_bf16 v[188:191], v[88:91], v[108:111], v[188:191]
    v_mfma_f32_16x16x32_bf16 v[192:195], v[92:95], v[96:99], v[192:195]
    v_mfma_f32_16x16x32_bf16 v[196:199], v[92:95], v[100:103], v[196:199]
    v_mfma_f32_16x16x32_bf16 v[200:203], v[92:95], v[104:107], v[200:203]
    v_mfma_f32_16x16x32_bf16 v[204:207], v[92:95], v[108:111], v[204:207]
    buffer_load_dwordx4 v[80:83], v8, s[12:15], s24 offen offset:2048
    buffer_load_dwordx4 v[84:87], v9, s[12:15], s24 offen offset:2048
    buffer_load_dwordx4 v[88:91], v10, s[12:15], s24 offen offset:2048
    buffer_load_dwordx4 v[92:95], v11, s[12:15], s24 offen offset:2048
    buffer_load_dwordx4 v[96:99], v12, s[12:15], s24 offen offset:2048
    buffer_load_dwordx4 v[100:103], v13, s[12:15], s24 offen offset:2048
    buffer_load_dwordx4 v[104:107], v14, s[12:15], s24 offen offset:2048
    buffer_load_dwordx4 v[108:111], v15, s[12:15], s24 offen offset:2048
    s_waitcnt vmcnt(24)
    v_mfma_f32_16x16x32_bf16 v[144:147], v[112:115], v[128:131], v[144:147]
    v_mfma_f32_16x16x32_bf16 v[148:151], v[112:115], v[132:135], v[148:151]
    v_mfma_f32_16x16x32_bf16 v[152:155], v[112:115], v[136:139], v[152:155]
    v_mfma_f32_16x16x32_bf16 v[156:159], v[112:115], v[140:143], v[156:159]
    v_mfma_f32_16x16x32_bf16 v[160:163], v[116:119], v[128:131], v[160:163]
    v_mfma_f32_16x16x32_bf16 v[164:167], v[116:119], v[132:135], v[164:167]
    v_mfma_f32_16x16x32_bf16 v[168:171], v[116:119], v[136:139], v[168:171]
    v_mfma_f32_16x16x32_bf16 v[172:175], v[116:119], v[140:143], v[172:175]
    v_mfma_f32_16x16x32_bf16 v[176:179], v[120:123], v[128:131], v[176:179]
    v_mfma_f32_16x16x32_bf16 v[180:183], v[120:123], v[132:135], v[180:183]
    v_mfma_f32_16x16x32_bf16 v[184:187], v[120:123], v[136:139], v[184:187]
    v_mfma_f32_16x16x32_bf16 v[188:191], v[120:123], v[140:143], v[188:191]
    v_mfma_f32_16x16x32_bf16 v[192:195], v[124:127], v[128:131], v[192:195]
    v_mfma_f32_16x16x32_bf16 v[196:199], v[124:127], v[132:135], v[196:199]
    v_mfma_f32_16x16x32_bf16 v[200:203], v[124:127], v[136:139], v[200:203]
    v_mfma_f32_16x16x32_bf16 v[204:207], v[124:127], v[140:143], v[204:207]
    s_cmp_lt_u32 s24, 16384
    s_cbranch_scc1 qkv_kernel_loop
    s_waitcnt vmcnt(0)
    s_nop 7
    s_nop 7
    s_cmp_eq_u32 s10, 2
    s_cbranch_scc1 qkv_epiV
    v_lshlrev_b32 v208, 4, v3
    v_lshrrev_b32 v209, 1, v2
    v_lshl_add_u32 v208, v209, 8, v208
    v_and_b32 v209, 1, v2
    v_lshl_add_u32 v208, v209, 3, v208
    s_mov_b32 s25, 0x1800000
    s_mov_b32 s26, 0x2800000
    s_cmp_eq_u32 s10, 0
    s_cselect_b32 s25, s25, s26
    s_cselect_b32 s26, 13, 14
    s_lshl_b32 s27, s8, 2
    s_lshl_b32 s28, s5, 1
    s_add_u32 s27, s27, s28
    s_add_u32 s27, s27, 0
    s_lshl_b32 s27, s27, 5
    s_add_u32 s27, s27, s11
    s_lshl_b32 s27, s27, s26
    s_add_u32 s27, s27, s25
    s_lshl_b32 s28, s4, 11
    s_add_u32 s27, s27, s28
    s_add_u32 s27, s27, 0
    v_cvt_pk_bf16_f32 v210, v144, v145
    v_cvt_pk_bf16_f32 v211, v146, v147
    v_cvt_pk_bf16_f32 v212, v160, v161
    v_cvt_pk_bf16_f32 v213, v162, v163
    v_cvt_pk_bf16_f32 v214, v176, v177
    v_cvt_pk_bf16_f32 v215, v178, v179
    v_cvt_pk_bf16_f32 v216, v192, v193
    v_cvt_pk_bf16_f32 v217, v194, v195
    buffer_store_dwordx2 v[210:211], v208, s[12:15], s27 offen offset:0 sc1
    buffer_store_dwordx2 v[212:213], v208, s[12:15], s27 offen offset:512 sc1
    buffer_store_dwordx2 v[214:215], v208, s[12:15], s27 offen offset:1024 sc1
    buffer_store_dwordx2 v[216:217], v208, s[12:15], s27 offen offset:1536 sc1
    s_nop 1
    s_lshl_b32 s27, s8, 2
    s_lshl_b32 s28, s5, 1
    s_add_u32 s27, s27, s28
    s_add_u32 s27, s27, 0
    s_lshl_b32 s27, s27, 5
    s_add_u32 s27, s27, s11
    s_lshl_b32 s27, s27, s26
    s_add_u32 s27, s27, s25
    s_lshl_b32 s28, s4, 11
    s_add_u32 s27, s27, s28
    s_add_u32 s27, s27, 4096
    v_cvt_pk_bf16_f32 v210, v148, v149
    v_cvt_pk_bf16_f32 v211, v150, v151
    v_cvt_pk_bf16_f32 v212, v164, v165
    v_cvt_pk_bf16_f32 v213, v166, v167
    v_cvt_pk_bf16_f32 v214, v180, v181
    v_cvt_pk_bf16_f32 v215, v182, v183
    v_cvt_pk_bf16_f32 v216, v196, v197
    v_cvt_pk_bf16_f32 v217, v198, v199
    buffer_store_dwordx2 v[210:211], v208, s[12:15], s27 offen offset:0 sc1
    buffer_store_dwordx2 v[212:213], v208, s[12:15], s27 offen offset:512 sc1
    buffer_store_dwordx2 v[214:215], v208, s[12:15], s27 offen offset:1024 sc1
    buffer_store_dwordx2 v[216:217], v208, s[12:15], s27 offen offset:1536 sc1
    s_nop 1
    s_lshl_b32 s27, s8, 2
    s_lshl_b32 s28, s5, 1
    s_add_u32 s27, s27, s28
    s_add_u32 s27, s27, 1
    s_lshl_b32 s27, s27, 5
    s_add_u32 s27, s27, s11
    s_lshl_b32 s27, s27, s26
    s_add_u32 s27, s27, s25
    s_lshl_b32 s28, s4, 11
    s_add_u32 s27, s27, s28
    s_add_u32 s27, s27, 0
    v_cvt_pk_bf16_f32 v210, v152, v153
    v_cvt_pk_bf16_f32 v211, v154, v155
    v_cvt_pk_bf16_f32 v212, v168, v169
    v_cvt_pk_bf16_f32 v213, v170, v171
    v_cvt_pk_bf16_f32 v214, v184, v185
    v_cvt_pk_bf16_f32 v215, v186, v187
    v_cvt_pk_bf16_f32 v216, v200, v201
    v_cvt_pk_bf16_f32 v217, v202, v203
    buffer_store_dwordx2 v[210:211], v208, s[12:15], s27 offen offset:0 sc1
    buffer_store_dwordx2 v[212:213], v208, s[12:15], s27 offen offset:512 sc1
    buffer_store_dwordx2 v[214:215], v208, s[12:15], s27 offen offset:1024 sc1
    buffer_store_dwordx2 v[216:217], v208, s[12:15], s27 offen offset:1536 sc1
    s_nop 1
    s_lshl_b32 s27, s8, 2
    s_lshl_b32 s28, s5, 1
    s_add_u32 s27, s27, s28
    s_add_u32 s27, s27, 1
    s_lshl_b32 s27, s27, 5
    s_add_u32 s27, s27, s11
    s_lshl_b32 s27, s27, s26
    s_add_u32 s27, s27, s25
    s_lshl_b32 s28, s4, 11
    s_add_u32 s27, s27, s28
    s_add_u32 s27, s27, 4096
    v_cvt_pk_bf16_f32 v210, v156, v157
    v_cvt_pk_bf16_f32 v211, v158, v159
    v_cvt_pk_bf16_f32 v212, v172, v173
    v_cvt_pk_bf16_f32 v213, v174, v175
    v_cvt_pk_bf16_f32 v214, v188, v189
    v_cvt_pk_bf16_f32 v215, v190, v191
    v_cvt_pk_bf16_f32 v216, v204, v205
    v_cvt_pk_bf16_f32 v217, v206, v207
    buffer_store_dwordx2 v[210:211], v208, s[12:15], s27 offen offset:0 sc1
    buffer_store_dwordx2 v[212:213], v208, s[12:15], s27 offen offset:512 sc1
    buffer_store_dwordx2 v[214:215], v208, s[12:15], s27 offen offset:1024 sc1
    buffer_store_dwordx2 v[216:217], v208, s[12:15], s27 offen offset:1536 sc1
    s_nop 1
    s_branch qkv_flag
qkv_epiV:
    v_lshlrev_b32 v208, 4, v1
    s_lshl_b32 s27, s8, 2
    s_lshl_b32 s28, s4, 1
    s_add_u32 s27, s27, s28
    s_add_u32 s27, s27, 0
    s_lshl_b32 s27, s27, 5
    s_add_u32 s27, s27, s11
    s_lshl_b32 s27, s27, 14
    s_add_u32 s27, s27, 0x2802000
    s_lshl_b32 s28, s5, 12
    s_add_u32 s27, s27, s28
    v_cvt_pk_bf16_f32 v210, v144, v145
    v_cvt_pk_bf16_f32 v211, v146, v147
    v_cvt_pk_bf16_f32 v212, v148, v149
    v_cvt_pk_bf16_f32 v213, v150, v151
    v_cvt_pk_bf16_f32 v214, v152, v153
    v_cvt_pk_bf16_f32 v215, v154, v155
    v_cvt_pk_bf16_f32 v216, v156, v157
    v_cvt_pk_bf16_f32 v217, v158, v159
    buffer_store_dwordx2 v[210:211], v208, s[12:15], s27 offen offset:0 sc1
    buffer_store_dwordx2 v[212:213], v208, s[12:15], s27 offen offset:1024 sc1
    buffer_store_dwordx2 v[214:215], v208, s[12:15], s27 offen offset:2048 sc1
    buffer_store_dwordx2 v[216:217], v208, s[12:15], s27 offen offset:3072 sc1
    s_nop 1
    s_lshl_b32 s27, s8, 2
    s_lshl_b32 s28, s4, 1
    s_add_u32 s27, s27, s28
    s_add_u32 s27, s27, 0
    s_lshl_b32 s27, s27, 5
    s_add_u32 s27, s27, s11
    s_lshl_b32 s27, s27, 14
    s_add_u32 s27, s27, 0x2802008
    s_lshl_b32 s28, s5, 12
    s_add_u32 s27, s27, s28
    v_cvt_pk_bf16_f32 v210, v160, v161
    v_cvt_pk_bf16_f32 v211, v162, v163
    v_cvt_pk_bf16_f32 v212, v164, v165
    v_cvt_pk_bf16_f32 v213, v166, v167
    v_cvt_pk_bf16_f32 v214, v168, v169
    v_cvt_pk_bf16_f32 v215, v170, v171
    v_cvt_pk_bf16_f32 v216, v172, v173
    v_cvt_pk_bf16_f32 v217, v174, v175
    buffer_store_dwordx2 v[210:211], v208, s[12:15], s27 offen offset:0 sc1
    buffer_store_dwordx2 v[212:213], v208, s[12:15], s27 offen offset:1024 sc1
    buffer_store_dwordx2 v[214:215], v208, s[12:15], s27 offen offset:2048 sc1
    buffer_store_dwordx2 v[216:217], v208, s[12:15], s27 offen offset:3072 sc1
    s_nop 1
    s_lshl_b32 s27, s8, 2
    s_lshl_b32 s28, s4, 1
    s_add_u32 s27, s27, s28
    s_add_u32 s27, s27, 1
    s_lshl_b32 s27, s27, 5
    s_add_u32 s27, s27, s11
    s_lshl_b32 s27, s27, 14
    s_add_u32 s27, s27, 0x2802000
    s_lshl_b32 s28, s5, 12
    s_add_u32 s27, s27, s28
    v_cvt_pk_bf16_f32 v210, v176, v177
    v_cvt_pk_bf16_f32 v211, v178, v179
    v_cvt_pk_bf16_f32 v212, v180, v181
    v_cvt_pk_bf16_f32 v213, v182, v183
    v_cvt_pk_bf16_f32 v214, v184, v185
    v_cvt_pk_bf16_f32 v215, v186, v187
    v_cvt_pk_bf16_f32 v216, v188, v189
    v_cvt_pk_bf16_f32 v217, v190, v191
    buffer_store_dwordx2 v[210:211], v208, s[12:15], s27 offen offset:0 sc1
    buffer_store_dwordx2 v[212:213], v208, s[12:15], s27 offen offset:1024 sc1
    buffer_store_dwordx2 v[214:215], v208, s[12:15], s27 offen offset:2048 sc1
    buffer_store_dwordx2 v[216:217], v208, s[12:15], s27 offen offset:3072 sc1
    s_nop 1
    s_lshl_b32 s27, s8, 2
    s_lshl_b32 s28, s4, 1
    s_add_u32 s27, s27, s28
    s_add_u32 s27, s27, 1
    s_lshl_b32 s27, s27, 5
    s_add_u32 s27, s27, s11
    s_lshl_b32 s27, s27, 14
    s_add_u32 s27, s27, 0x2802008
    s_lshl_b32 s28, s5, 12
    s_add_u32 s27, s27, s28
    v_cvt_pk_bf16_f32 v210, v192, v193
    v_cvt_pk_bf16_f32 v211, v194, v195
    v_cvt_pk_bf16_f32 v212, v196, v197
    v_cvt_pk_bf16_f32 v213, v198, v199
    v_cvt_pk_bf16_f32 v214, v200, v201
    v_cvt_pk_bf16_f32 v215, v202, v203
    v_cvt_pk_bf16_f32 v216, v204, v205
    v_cvt_pk_bf16_f32 v217, v206, v207
    buffer_store_dwordx2 v[210:211], v208, s[12:15], s27 offen offset:0 sc1
    buffer_store_dwordx2 v[212:213], v208, s[12:15], s27 offen offset:1024 sc1
    buffer_store_dwordx2 v[214:215], v208, s[12:15], s27 offen offset:2048 sc1
    buffer_store_dwordx2 v[216:217], v208, s[12:15], s27 offen offset:3072 sc1
    s_nop 1
qkv_flag:
    s_waitcnt vmcnt(0)
    s_barrier
    s_cmp_eq_u32 s10, 0
    s_cbranch_scc1 qkv_kernel_end
    s_cmp_lg_u32 s3, 0
    s_cbranch_scc1 qkv_kernel_end
    s_lshl_b32 s27, s8, 1
    s_add_u32 s27, s27, s10
    s_sub_u32 s27, s27, 1
    s_lshl_b32 s27, s27, 5
    s_add_u32 s27, s27, s11
    s_lshl_b32 s27, s27, 2
    s_add_u32 s27, s27, 0x8104000
    s_mov_b64 exec, 1
    v_mov_b32 v208, 0
    v_mov_b32 v209, 1
    buffer_store_dword v209, v208, s[12:15], s27 offen sc1
qkv_kernel_end:
W_loop:
    s_waitcnt vmcnt(0) lgkmcnt(0)
    s_barrier
    v_lshrrev_b32 v4, 6, v0
    s_nop 0
    v_readfirstlane_b32 s3, v4
    s_cmp_lg_u32 s3, 0
    s_cbranch_scc1 W_1
    s_mov_b64 exec, 1
    v_mov_b32 v4, 1
    v_mov_b32 v5, 192
    buffer_atomic_add v4, v5, s[80:83], 0 offen sc0 sc1
    s_waitcnt vmcnt(0)
    v_mov_b32 v5, 0
    ds_write_b32 v5, v4
    s_mov_b64 exec, -1
    W_1:
    s_waitcnt lgkmcnt(0)
    s_barrier
    v_mov_b32 v5, 0
    ds_read_b32 v4, v5
    s_waitcnt lgkmcnt(0)
    v_readfirstlane_b32 s2, v4
    s_cmp_ge_u32 s2, 1536
    s_cbranch_scc1 W_end
    s_add_u32 s2, s2, 256
    s_branch qkv_kernel_entry
    W_end:
    s_endpgm
.globl attn_kernel
.p2align 8
.type attn_kernel,@function
attn_kernel:
    s_load_dwordx2 s[38:39], s[0:1], 104
    s_cmp_ge_u32 s2, 512
    s_cbranch_scc1 attn_end
    v_and_b32 v1, 63, v0
    v_lshrrev_b32 v2, 4, v1
    v_and_b32 v3, 15, v1
    v_lshrrev_b32 v4, 6, v0
    s_nop 0
    v_readfirstlane_b32 s3, v4
    s_waitcnt lgkmcnt(0)
    s_mov_b32 s12, s38
    s_mov_b32 s13, s39
    s_mov_b32 s14, 0x10000000
    s_mov_b32 s15, 0x20000
    s_lshl_b32 s4, s2, 2
    s_add_u32 s4, s4, s3
    s_lshr_b32 s5, s4, 5
    s_and_b32 s6, s4, 31
    v_xor_b32 v5, 32, v1
    v_lshlrev_b32 v5, 2, v5
    v_lshlrev_b32 v6, 4, v1
    s_lshl_b32 s8, s6, 8
    s_lshl_b32 s7, s4, 13
    s_add_u32 s10, s7, 0x1800000
    s_lshl_b32 s7, s4, 14
    s_add_u32 s9, s7, 0x2800000
    s_add_u32 s16, s9, 4096
    s_add_u32 s17, s10, 4096
    s_add_u32 s19, s9, 8192
    s_add_u32 s20, s9, 12288
    buffer_load_dwordx4 v[16:19], v6, s[12:15], s9 offen offset:0
    buffer_load_dwordx4 v[32:35], v6, s[12:15], s16 offen offset:0
    buffer_load_dwordx4 v[64:67], v6, s[12:15], s10 offen offset:0
    buffer_load_dwordx4 v[80:83], v6, s[12:15], s17 offen offset:0
    buffer_load_dwordx4 v[20:23], v6, s[12:15], s9 offen offset:1024
    buffer_load_dwordx4 v[36:39], v6, s[12:15], s16 offen offset:1024
    buffer_load_dwordx4 v[68:71], v6, s[12:15], s10 offen offset:1024
    buffer_load_dwordx4 v[84:87], v6, s[12:15], s17 offen offset:1024
    buffer_load_dwordx4 v[24:27], v6, s[12:15], s9 offen offset:2048
    buffer_load_dwordx4 v[40:43], v6, s[12:15], s16 offen offset:2048
    buffer_load_dwordx4 v[72:75], v6, s[12:15], s10 offen offset:2048
    buffer_load_dwordx4 v[88:91], v6, s[12:15], s17 offen offset:2048
    buffer_load_dwordx4 v[28:31], v6, s[12:15], s9 offen offset:3072
    buffer_load_dwordx4 v[44:47], v6, s[12:15], s16 offen offset:3072
    buffer_load_dwordx4 v[76:79], v6, s[12:15], s10 offen offset:3072
    buffer_load_dwordx4 v[92:95], v6, s[12:15], s17 offen offset:3072
    buffer_load_dwordx4 v[96:99], v6, s[12:15], s19 offen offset:0
    buffer_load_dwordx4 v[100:103], v6, s[12:15], s19 offen offset:1024
    buffer_load_dwordx4 v[104:107], v6, s[12:15], s19 offen offset:2048
    buffer_load_dwordx4 v[108:111], v6, s[12:15], s19 offen offset:3072
    buffer_load_dwordx4 v[112:115], v6, s[12:15], s20 offen offset:0
    buffer_load_dwordx4 v[116:119], v6, s[12:15], s20 offen offset:1024
    buffer_load_dwordx4 v[120:123], v6, s[12:15], s20 offen offset:2048
    buffer_load_dwordx4 v[124:127], v6, s[12:15], s20 offen offset:3072
    v_and_b32 v7, 7, v1
    v_lshlrev_b32 v7, 8, v7
    v_lshl_add_u32 v7, v2, 4, v7
    s_lshl_b32 s18, s4, 11
    s_add_u32 s18, s18, 0x4800000
    buffer_load_dwordx4 v[48:51], v7, s[12:15], s18 offen offset:0
    buffer_load_dwordx4 v[52:55], v7, s[12:15], s18 offen offset:64
    buffer_load_dwordx4 v[56:59], v7, s[12:15], s18 offen offset:128
    buffer_load_dwordx4 v[60:63], v7, s[12:15], s18 offen offset:192
    v_lshlrev_b32 v9, 4, v3
    v_lshl_add_u32 v9, v2, 3, v9
    v_and_b32 v10, 1, v2
    v_lshlrev_b32 v9, 4, v3
    v_lshl_add_u32 v9, v10, 3, v9
    s_lshl_b32 s21, s5, 16
    s_lshl_b32 s22, s6, 11
    s_add_u32 s21, s21, s22
    s_add_u32 s21, s21, 0x4c00000
    buffer_load_dwordx2 v[128:129], v9, s[12:15], s21 offen offset:0
    v_mov_b32 v130, 0
    v_mov_b32 v131, 0
    buffer_load_dwordx2 v[132:133], v9, s[12:15], s21 offen offset:256
    v_mov_b32 v134, 0
    v_mov_b32 v135, 0
    buffer_load_dwordx2 v[136:137], v9, s[12:15], s21 offen offset:512
    v_mov_b32 v138, 0
    v_mov_b32 v139, 0
    buffer_load_dwordx2 v[140:141], v9, s[12:15], s21 offen offset:768
    v_mov_b32 v142, 0
    v_mov_b32 v143, 0
    buffer_load_dwordx2 v[144:145], v9, s[12:15], s21 offen offset:1024
    v_mov_b32 v146, 0
    v_mov_b32 v147, 0
    buffer_load_dwordx2 v[148:149], v9, s[12:15], s21 offen offset:1280
    v_mov_b32 v150, 0
    v_mov_b32 v151, 0
    buffer_load_dwordx2 v[152:153], v9, s[12:15], s21 offen offset:1536
    v_mov_b32 v154, 0
    v_mov_b32 v155, 0
    buffer_load_dwordx2 v[156:157], v9, s[12:15], s21 offen offset:1792
    v_mov_b32 v158, 0
    v_mov_b32 v159, 0
    v_lshlrev_b32 v11, 4, v1
    s_lshl_b32 s23, s5, 18
    s_lshl_b32 s24, s6, 12
    s_add_u32 s23, s23, s24
    s_add_u32 s23, s23, 0x5000000
    v_cmp_gt_u32 vcc, 2, v2
    s_waitcnt vmcnt(0)
    v_cndmask_b32 v128, 0, v128, vcc
    v_cndmask_b32 v129, 0, v129, vcc
    v_cndmask_b32 v132, 0, v132, vcc
    v_cndmask_b32 v133, 0, v133, vcc
    v_cndmask_b32 v136, 0, v136, vcc
    v_cndmask_b32 v137, 0, v137, vcc
    v_cndmask_b32 v140, 0, v140, vcc
    v_cndmask_b32 v141, 0, v141, vcc
    v_cndmask_b32 v144, 0, v144, vcc
    v_cndmask_b32 v145, 0, v145, vcc
    v_cndmask_b32 v148, 0, v148, vcc
    v_cndmask_b32 v149, 0, v149, vcc
    v_cndmask_b32 v152, 0, v152, vcc
    v_cndmask_b32 v153, 0, v153, vcc
    v_cndmask_b32 v156, 0, v156, vcc
    v_cndmask_b32 v157, 0, v157, vcc
    v_lshlrev_b32 v13, 2, v2
    v_sub_u32 v12, v3, v13
    v_add_u32 v12, 0, v12
    v_mfma_f32_16x16x32_bf16 v[160:163], v[16:19], v[64:67], 0
    v_mfma_f32_16x16x32_bf16 v[160:163], v[20:23], v[68:71], v[160:163]
    v_mfma_f32_16x16x32_bf16 v[160:163], v[24:27], v[72:75], v[160:163]
    v_mfma_f32_16x16x32_bf16 v[160:163], v[28:31], v[76:79], v[160:163]
    v_mfma_f32_16x16x32_bf16 v[164:167], v[32:35], v[64:67], 0
    v_mfma_f32_16x16x32_bf16 v[164:167], v[36:39], v[68:71], v[164:167]
    v_mfma_f32_16x16x32_bf16 v[164:167], v[40:43], v[72:75], v[164:167]
    v_mfma_f32_16x16x32_bf16 v[164:167], v[44:47], v[76:79], v[164:167]
    v_mfma_f32_16x16x32_bf16 v[168:171], v[48:51], v[64:67], 0
    v_mfma_f32_16x16x32_bf16 v[168:171], v[52:55], v[68:71], v[168:171]
    v_mfma_f32_16x16x32_bf16 v[168:171], v[56:59], v[72:75], v[168:171]
    v_mfma_f32_16x16x32_bf16 v[168:171], v[60:63], v[76:79], v[168:171]
    s_nop 7
    s_nop 3
    v_cvt_pk_bf16_f32 v212, v160, v161
    v_lshlrev_b32 v160, 16, v212
    v_and_b32 v161, 0xffff0000, v212
    v_mul_f32 v160, 0x3db504f3, v160
    v_mul_f32 v161, 0x3db504f3, v161
    v_cvt_pk_bf16_f32 v212, v162, v163
    v_lshlrev_b32 v162, 16, v212
    v_and_b32 v163, 0xffff0000, v212
    v_mul_f32 v162, 0x3db504f3, v162
    v_mul_f32 v163, 0x3db504f3, v163
    v_cvt_pk_bf16_f32 v212, v164, v165
    v_lshlrev_b32 v164, 16, v212
    v_and_b32 v165, 0xffff0000, v212
    v_mul_f32 v164, 0x3db504f3, v164
    v_mul_f32 v165, 0x3db504f3, v165
    v_cvt_pk_bf16_f32 v212, v166, v167
    v_lshlrev_b32 v166, 16, v212
    v_and_b32 v167, 0xffff0000, v212
    v_mul_f32 v166, 0x3db504f3, v166
    v_mul_f32 v167, 0x3db504f3, v167
    v_cvt_pk_bf16_f32 v212, v168, v169
    v_lshlrev_b32 v168, 16, v212
    v_and_b32 v169, 0xffff0000, v212
    v_mul_f32 v168, 0x3db504f3, v168
    v_mul_f32 v169, 0x3db504f3, v169
    v_cvt_pk_bf16_f32 v212, v170, v171
    v_lshlrev_b32 v170, 16, v212
    v_and_b32 v171, 0xffff0000, v212
    v_mul_f32 v170, 0x3db504f3, v170
    v_mul_f32 v171, 0x3db504f3, v171
    v_cvt_pk_bf16_f32 v212, v160, v161
    v_lshlrev_b32 v160, 16, v212
    v_and_b32 v161, 0xffff0000, v212
    v_cvt_pk_bf16_f32 v212, v162, v163
    v_lshlrev_b32 v162, 16, v212
    v_and_b32 v163, 0xffff0000, v212
    v_cvt_pk_bf16_f32 v212, v164, v165
    v_lshlrev_b32 v164, 16, v212
    v_and_b32 v165, 0xffff0000, v212
    v_cvt_pk_bf16_f32 v212, v166, v167
    v_lshlrev_b32 v166, 16, v212
    v_and_b32 v167, 0xffff0000, v212
    v_cvt_pk_bf16_f32 v212, v168, v169
    v_lshlrev_b32 v168, 16, v212
    v_and_b32 v169, 0xffff0000, v212
    v_cvt_pk_bf16_f32 v212, v170, v171
    v_lshlrev_b32 v170, 16, v212
    v_and_b32 v171, 0xffff0000, v212
    v_mov_b32 v215, 0xce6e6b28
    v_cmp_le_i32 vcc, 0, v12
    s_nop 1
    v_cndmask_b32 v160, v215, v160, vcc
    v_cmp_le_i32 vcc, 1, v12
    s_nop 1
    v_cndmask_b32 v161, v215, v161, vcc
    v_cmp_le_i32 vcc, 2, v12
    s_nop 1
    v_cndmask_b32 v162, v215, v162, vcc
    v_cmp_le_i32 vcc, 3, v12
    s_nop 1
    v_cndmask_b32 v163, v215, v163, vcc
    v_cmp_le_i32 vcc, 16, v12
    s_nop 1
    v_cndmask_b32 v164, v215, v164, vcc
    v_cmp_le_i32 vcc, 17, v12
    s_nop 1
    v_cndmask_b32 v165, v215, v165, vcc
    v_cmp_le_i32 vcc, 18, v12
    s_nop 1
    v_cndmask_b32 v166, v215, v166, vcc
    v_cmp_le_i32 vcc, 19, v12
    s_nop 1
    v_cndmask_b32 v167, v215, v167, vcc
    v_cmp_gt_u32 vcc, 2, v2
    s_nop 1
    v_cndmask_b32 v168, v215, v168, vcc
    v_cndmask_b32 v169, v215, v169, vcc
    v_cndmask_b32 v170, v215, v170, vcc
    v_cndmask_b32 v171, v215, v171, vcc
    v_max3_f32 v213, v160, v161, v162
    v_max3_f32 v213, v213, v163, v164
    v_max3_f32 v213, v213, v165, v166
    v_max3_f32 v213, v213, v167, v168
    v_max3_f32 v213, v213, v169, v170
    v_max_f32 v213, v213, v171
    v_mov_b32 v212, v213
    v_mov_b32 v214, v213
    s_nop 1
    v_permlane16_swap_b32 v212, v214
    s_nop 1
    v_max_f32 v213, v212, v214
    v_mov_b32 v212, v213
    v_mov_b32 v214, v213
    s_nop 1
    v_permlane32_swap_b32 v212, v214
    s_nop 1
    v_max_f32 v213, v212, v214
    v_mul_f32 v213, 0xbfb8aa3b, v213
    v_mov_b32 v215, 0x3fb8aa3b
    v_fma_f32 v160, v160, v215, v213
    v_exp_f32 v160, v160
    v_fma_f32 v161, v161, v215, v213
    v_exp_f32 v161, v161
    v_fma_f32 v162, v162, v215, v213
    v_exp_f32 v162, v162
    v_fma_f32 v163, v163, v215, v213
    v_exp_f32 v163, v163
    v_fma_f32 v164, v164, v215, v213
    v_exp_f32 v164, v164
    v_fma_f32 v165, v165, v215, v213
    v_exp_f32 v165, v165
    v_fma_f32 v166, v166, v215, v213
    v_exp_f32 v166, v166
    v_fma_f32 v167, v167, v215, v213
    v_exp_f32 v167, v167
    v_fma_f32 v168, v168, v215, v213
    v_exp_f32 v168, v168
    v_fma_f32 v169, v169, v215, v213
    v_exp_f32 v169, v169
    v_fma_f32 v170, v170, v215, v213
    v_exp_f32 v170, v170
    v_fma_f32 v171, v171, v215, v213
    v_exp_f32 v171, v171
    s_nop 1
    v_add_f32 v214, v160, v161
    v_add_f32 v214, v214, v162
    v_add_f32 v214, v214, v163
    v_add_f32 v214, v214, v164
    v_add_f32 v214, v214, v165
    v_add_f32 v214, v214, v166
    v_add_f32 v214, v214, v167
    v_add_f32 v214, v214, v168
    v_add_f32 v214, v214, v169
    v_add_f32 v214, v214, v170
    v_add_f32 v214, v214, v171
    v_mov_b32 v212, v214
    v_mov_b32 v213, v214
    s_nop 1
    v_permlane16_swap_b32 v212, v213
    s_nop 1
    v_add_f32 v214, v212, v213
    v_mov_b32 v212, v214
    v_mov_b32 v213, v214
    s_nop 1
    v_permlane32_swap_b32 v212, v213
    s_nop 1
    v_add_f32 v214, v212, v213
    v_rcp_f32 v214, v214
    s_nop 1
    v_mul_f32 v160, v160, v214
    v_mul_f32 v161, v161, v214
    v_mul_f32 v162, v162, v214
    v_mul_f32 v163, v163, v214
    v_mul_f32 v164, v164, v214
    v_mul_f32 v165, v165, v214
    v_mul_f32 v166, v166, v214
    v_mul_f32 v167, v167, v214
    v_mul_f32 v168, v168, v214
    v_mul_f32 v169, v169, v214
    v_mul_f32 v170, v170, v214
    v_mul_f32 v171, v171, v214
    v_cvt_pk_bf16_f32 v172, v160, v161
    v_cvt_pk_bf16_f32 v173, v162, v163
    v_cvt_pk_bf16_f32 v174, v164, v165
    v_cvt_pk_bf16_f32 v175, v166, v167
    v_cvt_pk_bf16_f32 v176, v168, v169
    v_cvt_pk_bf16_f32 v177, v170, v171
    v_mov_b32 v178, 0
    v_mov_b32 v179, 0
    s_nop 1
    v_mfma_f32_16x16x32_bf16 v[180:183], v[96:99], v[172:175], 0
    v_mfma_f32_16x16x32_bf16 v[184:187], v[100:103], v[172:175], 0
    v_mfma_f32_16x16x32_bf16 v[188:191], v[104:107], v[172:175], 0
    v_mfma_f32_16x16x32_bf16 v[192:195], v[108:111], v[172:175], 0
    v_mfma_f32_16x16x32_bf16 v[196:199], v[112:115], v[172:175], 0
    v_mfma_f32_16x16x32_bf16 v[200:203], v[116:119], v[172:175], 0
    v_mfma_f32_16x16x32_bf16 v[204:207], v[120:123], v[172:175], 0
    v_mfma_f32_16x16x32_bf16 v[208:211], v[124:127], v[172:175], 0
    v_mfma_f32_16x16x32_bf16 v[180:183], v[128:131], v[176:179], v[180:183]
    v_mfma_f32_16x16x32_bf16 v[184:187], v[132:135], v[176:179], v[184:187]
    v_mfma_f32_16x16x32_bf16 v[188:191], v[136:139], v[176:179], v[188:191]
    v_mfma_f32_16x16x32_bf16 v[192:195], v[140:143], v[176:179], v[192:195]
    v_mfma_f32_16x16x32_bf16 v[196:199], v[144:147], v[176:179], v[196:199]
    v_mfma_f32_16x16x32_bf16 v[200:203], v[148:151], v[176:179], v[200:203]
    v_mfma_f32_16x16x32_bf16 v[204:207], v[152:155], v[176:179], v[204:207]
    v_mfma_f32_16x16x32_bf16 v[208:211], v[156:159], v[176:179], v[208:211]
    s_nop 7
    s_nop 3
    v_cvt_pk_bf16_f32 v160, v180, v181
    v_cvt_pk_bf16_f32 v161, v182, v183
    v_cvt_pk_bf16_f32 v162, v184, v185
    v_cvt_pk_bf16_f32 v163, v186, v187
    buffer_store_dwordx4 v[160:163], v11, s[12:15], s23 offen offset:0
    s_nop 1
    v_cvt_pk_bf16_f32 v160, v188, v189
    v_cvt_pk_bf16_f32 v161, v190, v191
    v_cvt_pk_bf16_f32 v162, v192, v193
    v_cvt_pk_bf16_f32 v163, v194, v195
    buffer_store_dwordx4 v[160:163], v11, s[12:15], s23 offen offset:1024
    s_nop 1
    v_cvt_pk_bf16_f32 v160, v196, v197
    v_cvt_pk_bf16_f32 v161, v198, v199
    v_cvt_pk_bf16_f32 v162, v200, v201
    v_cvt_pk_bf16_f32 v163, v202, v203
    buffer_store_dwordx4 v[160:163], v11, s[12:15], s23 offen offset:2048
    s_nop 1
    v_cvt_pk_bf16_f32 v160, v204, v205
    v_cvt_pk_bf16_f32 v161, v206, v207
    v_cvt_pk_bf16_f32 v162, v208, v209
    v_cvt_pk_bf16_f32 v163, v210, v211
    buffer_store_dwordx4 v[160:163], v11, s[12:15], s23 offen offset:3072
    s_nop 1
    s_add_u32 s23, s23, 131072
    v_lshlrev_b32 v13, 2, v2
    v_sub_u32 v12, v3, v13
    v_add_u32 v12, 16, v12
    v_mfma_f32_16x16x32_bf16 v[160:163], v[16:19], v[80:83], 0
    v_mfma_f32_16x16x32_bf16 v[160:163], v[20:23], v[84:87], v[160:163]
    v_mfma_f32_16x16x32_bf16 v[160:163], v[24:27], v[88:91], v[160:163]
    v_mfma_f32_16x16x32_bf16 v[160:163], v[28:31], v[92:95], v[160:163]
    v_mfma_f32_16x16x32_bf16 v[164:167], v[32:35], v[80:83], 0
    v_mfma_f32_16x16x32_bf16 v[164:167], v[36:39], v[84:87], v[164:167]
    v_mfma_f32_16x16x32_bf16 v[164:167], v[40:43], v[88:91], v[164:167]
    v_mfma_f32_16x16x32_bf16 v[164:167], v[44:47], v[92:95], v[164:167]
    v_mfma_f32_16x16x32_bf16 v[168:171], v[48:51], v[80:83], 0
    v_mfma_f32_16x16x32_bf16 v[168:171], v[52:55], v[84:87], v[168:171]
    v_mfma_f32_16x16x32_bf16 v[168:171], v[56:59], v[88:91], v[168:171]
    v_mfma_f32_16x16x32_bf16 v[168:171], v[60:63], v[92:95], v[168:171]
    s_nop 7
    s_nop 3
    v_cvt_pk_bf16_f32 v212, v160, v161
    v_lshlrev_b32 v160, 16, v212
    v_and_b32 v161, 0xffff0000, v212
    v_mul_f32 v160, 0x3db504f3, v160
    v_mul_f32 v161, 0x3db504f3, v161
    v_cvt_pk_bf16_f32 v212, v162, v163
    v_lshlrev_b32 v162, 16, v212
    v_and_b32 v163, 0xffff0000, v212
    v_mul_f32 v162, 0x3db504f3, v162
    v_mul_f32 v163, 0x3db504f3, v163
    v_cvt_pk_bf16_f32 v212, v164, v165
    v_lshlrev_b32 v164, 16, v212
    v_and_b32 v165, 0xffff0000, v212
    v_mul_f32 v164, 0x3db504f3, v164
    v_mul_f32 v165, 0x3db504f3, v165
    v_cvt_pk_bf16_f32 v212, v166, v167
    v_lshlrev_b32 v166, 16, v212
    v_and_b32 v167, 0xffff0000, v212
    v_mul_f32 v166, 0x3db504f3, v166
    v_mul_f32 v167, 0x3db504f3, v167
    v_cvt_pk_bf16_f32 v212, v168, v169
    v_lshlrev_b32 v168, 16, v212
    v_and_b32 v169, 0xffff0000, v212
    v_mul_f32 v168, 0x3db504f3, v168
    v_mul_f32 v169, 0x3db504f3, v169
    v_cvt_pk_bf16_f32 v212, v170, v171
    v_lshlrev_b32 v170, 16, v212
    v_and_b32 v171, 0xffff0000, v212
    v_mul_f32 v170, 0x3db504f3, v170
    v_mul_f32 v171, 0x3db504f3, v171
    v_cvt_pk_bf16_f32 v212, v160, v161
    v_lshlrev_b32 v160, 16, v212
    v_and_b32 v161, 0xffff0000, v212
    v_cvt_pk_bf16_f32 v212, v162, v163
    v_lshlrev_b32 v162, 16, v212
    v_and_b32 v163, 0xffff0000, v212
    v_cvt_pk_bf16_f32 v212, v164, v165
    v_lshlrev_b32 v164, 16, v212
    v_and_b32 v165, 0xffff0000, v212
    v_cvt_pk_bf16_f32 v212, v166, v167
    v_lshlrev_b32 v166, 16, v212
    v_and_b32 v167, 0xffff0000, v212
    v_cvt_pk_bf16_f32 v212, v168, v169
    v_lshlrev_b32 v168, 16, v212
    v_and_b32 v169, 0xffff0000, v212
    v_cvt_pk_bf16_f32 v212, v170, v171
    v_lshlrev_b32 v170, 16, v212
    v_and_b32 v171, 0xffff0000, v212
    v_mov_b32 v215, 0xce6e6b28
    v_cmp_le_i32 vcc, 0, v12
    s_nop 1
    v_cndmask_b32 v160, v215, v160, vcc
    v_cmp_le_i32 vcc, 1, v12
    s_nop 1
    v_cndmask_b32 v161, v215, v161, vcc
    v_cmp_le_i32 vcc, 2, v12
    s_nop 1
    v_cndmask_b32 v162, v215, v162, vcc
    v_cmp_le_i32 vcc, 3, v12
    s_nop 1
    v_cndmask_b32 v163, v215, v163, vcc
    v_cmp_le_i32 vcc, 16, v12
    s_nop 1
    v_cndmask_b32 v164, v215, v164, vcc
    v_cmp_le_i32 vcc, 17, v12
    s_nop 1
    v_cndmask_b32 v165, v215, v165, vcc
    v_cmp_le_i32 vcc, 18, v12
    s_nop 1
    v_cndmask_b32 v166, v215, v166, vcc
    v_cmp_le_i32 vcc, 19, v12
    s_nop 1
    v_cndmask_b32 v167, v215, v167, vcc
    v_cmp_gt_u32 vcc, 2, v2
    s_nop 1
    v_cndmask_b32 v168, v215, v168, vcc
    v_cndmask_b32 v169, v215, v169, vcc
    v_cndmask_b32 v170, v215, v170, vcc
    v_cndmask_b32 v171, v215, v171, vcc
    v_max3_f32 v213, v160, v161, v162
    v_max3_f32 v213, v213, v163, v164
    v_max3_f32 v213, v213, v165, v166
    v_max3_f32 v213, v213, v167, v168
    v_max3_f32 v213, v213, v169, v170
    v_max_f32 v213, v213, v171
    v_mov_b32 v212, v213
    v_mov_b32 v214, v213
    s_nop 1
    v_permlane16_swap_b32 v212, v214
    s_nop 1
    v_max_f32 v213, v212, v214
    v_mov_b32 v212, v213
    v_mov_b32 v214, v213
    s_nop 1
    v_permlane32_swap_b32 v212, v214
    s_nop 1
    v_max_f32 v213, v212, v214
    v_mul_f32 v213, 0xbfb8aa3b, v213
    v_mov_b32 v215, 0x3fb8aa3b
    v_fma_f32 v160, v160, v215, v213
    v_exp_f32 v160, v160
    v_fma_f32 v161, v161, v215, v213
    v_exp_f32 v161, v161
    v_fma_f32 v162, v162, v215, v213
    v_exp_f32 v162, v162
    v_fma_f32 v163, v163, v215, v213
    v_exp_f32 v163, v163
    v_fma_f32 v164, v164, v215, v213
    v_exp_f32 v164, v164
    v_fma_f32 v165, v165, v215, v213
    v_exp_f32 v165, v165
    v_fma_f32 v166, v166, v215, v213
    v_exp_f32 v166, v166
    v_fma_f32 v167, v167, v215, v213
    v_exp_f32 v167, v167
    v_fma_f32 v168, v168, v215, v213
    v_exp_f32 v168, v168
    v_fma_f32 v169, v169, v215, v213
    v_exp_f32 v169, v169
    v_fma_f32 v170, v170, v215, v213
    v_exp_f32 v170, v170
    v_fma_f32 v171, v171, v215, v213
    v_exp_f32 v171, v171
    s_nop 1
    v_add_f32 v214, v160, v161
    v_add_f32 v214, v214, v162
    v_add_f32 v214, v214, v163
    v_add_f32 v214, v214, v164
    v_add_f32 v214, v214, v165
    v_add_f32 v214, v214, v166
    v_add_f32 v214, v214, v167
    v_add_f32 v214, v214, v168
    v_add_f32 v214, v214, v169
    v_add_f32 v214, v214, v170
    v_add_f32 v214, v214, v171
    v_mov_b32 v212, v214
    v_mov_b32 v213, v214
    s_nop 1
    v_permlane16_swap_b32 v212, v213
    s_nop 1
    v_add_f32 v214, v212, v213
    v_mov_b32 v212, v214
    v_mov_b32 v213, v214
    s_nop 1
    v_permlane32_swap_b32 v212, v213
    s_nop 1
    v_add_f32 v214, v212, v213
    v_rcp_f32 v214, v214
    s_nop 1
    v_mul_f32 v160, v160, v214
    v_mul_f32 v161, v161, v214
    v_mul_f32 v162, v162, v214
    v_mul_f32 v163, v163, v214
    v_mul_f32 v164, v164, v214
    v_mul_f32 v165, v165, v214
    v_mul_f32 v166, v166, v214
    v_mul_f32 v167, v167, v214
    v_mul_f32 v168, v168, v214
    v_mul_f32 v169, v169, v214
    v_mul_f32 v170, v170, v214
    v_mul_f32 v171, v171, v214
    v_cvt_pk_bf16_f32 v172, v160, v161
    v_cvt_pk_bf16_f32 v173, v162, v163
    v_cvt_pk_bf16_f32 v174, v164, v165
    v_cvt_pk_bf16_f32 v175, v166, v167
    v_cvt_pk_bf16_f32 v176, v168, v169
    v_cvt_pk_bf16_f32 v177, v170, v171
    v_mov_b32 v178, 0
    v_mov_b32 v179, 0
    s_nop 1
    v_mfma_f32_16x16x32_bf16 v[180:183], v[96:99], v[172:175], 0
    v_mfma_f32_16x16x32_bf16 v[184:187], v[100:103], v[172:175], 0
    v_mfma_f32_16x16x32_bf16 v[188:191], v[104:107], v[172:175], 0
    v_mfma_f32_16x16x32_bf16 v[192:195], v[108:111], v[172:175], 0
    v_mfma_f32_16x16x32_bf16 v[196:199], v[112:115], v[172:175], 0
    v_mfma_f32_16x16x32_bf16 v[200:203], v[116:119], v[172:175], 0
    v_mfma_f32_16x16x32_bf16 v[204:207], v[120:123], v[172:175], 0
    v_mfma_f32_16x16x32_bf16 v[208:211], v[124:127], v[172:175], 0
    v_mfma_f32_16x16x32_bf16 v[180:183], v[128:131], v[176:179], v[180:183]
    v_mfma_f32_16x16x32_bf16 v[184:187], v[132:135], v[176:179], v[184:187]
    v_mfma_f32_16x16x32_bf16 v[188:191], v[136:139], v[176:179], v[188:191]
    v_mfma_f32_16x16x32_bf16 v[192:195], v[140:143], v[176:179], v[192:195]
    v_mfma_f32_16x16x32_bf16 v[196:199], v[144:147], v[176:179], v[196:199]
    v_mfma_f32_16x16x32_bf16 v[200:203], v[148:151], v[176:179], v[200:203]
    v_mfma_f32_16x16x32_bf16 v[204:207], v[152:155], v[176:179], v[204:207]
    v_mfma_f32_16x16x32_bf16 v[208:211], v[156:159], v[176:179], v[208:211]
    s_nop 7
    s_nop 3
    v_cvt_pk_bf16_f32 v160, v180, v181
    v_cvt_pk_bf16_f32 v161, v182, v183
    v_cvt_pk_bf16_f32 v162, v184, v185
    v_cvt_pk_bf16_f32 v163, v186, v187
    buffer_store_dwordx4 v[160:163], v11, s[12:15], s23 offen offset:0
    s_nop 1
    v_cvt_pk_bf16_f32 v160, v188, v189
    v_cvt_pk_bf16_f32 v161, v190, v191
    v_cvt_pk_bf16_f32 v162, v192, v193
    v_cvt_pk_bf16_f32 v163, v194, v195
    buffer_store_dwordx4 v[160:163], v11, s[12:15], s23 offen offset:1024
    s_nop 1
    v_cvt_pk_bf16_f32 v160, v196, v197
    v_cvt_pk_bf16_f32 v161, v198, v199
    v_cvt_pk_bf16_f32 v162, v200, v201
    v_cvt_pk_bf16_f32 v163, v202, v203
    buffer_store_dwordx4 v[160:163], v11, s[12:15], s23 offen offset:2048
    s_nop 1
    v_cvt_pk_bf16_f32 v160, v204, v205
    v_cvt_pk_bf16_f32 v161, v206, v207
    v_cvt_pk_bf16_f32 v162, v208, v209
    v_cvt_pk_bf16_f32 v163, v210, v211
    buffer_store_dwordx4 v[160:163], v11, s[12:15], s23 offen offset:3072
    s_nop 1
    s_add_u32 s23, s23, 131072
attn_end:
    s_endpgm
.globl wo_kernel
.p2align 8
.type wo_kernel,@function
wo_kernel:
    s_load_dwordx2 s[38:39], s[0:1], 104
    s_load_dwordx2 s[36:37], s[0:1], 88
    s_cmp_ge_u32 s2, 256
    s_cbranch_scc1 wo_kernel_end
    v_and_b32 v1, 63, v0
    v_lshrrev_b32 v2, 4, v1
    v_and_b32 v3, 15, v1
    v_lshrrev_b32 v4, 6, v0
    s_nop 0
    v_readfirstlane_b32 s3, v4
    s_waitcnt lgkmcnt(0)
    s_mov_b32 s12, s38
    s_mov_b32 s13, s39
    s_mov_b32 s14, 0x10000000
    s_mov_b32 s15, 0x20000
    s_lshr_b32 s4, s3, 1
    s_and_b32 s5, s3, 1
    s_and_b32 s8, s2, 15
    s_lshr_b32 s9, s2, 4
    s_and_b32 s10, s9, 3
    s_lshr_b32 s11, s9, 2
    s_lshl_b32 s16, s11, 15
    s_lshl_b32 s20, s10, 20
    s_add_u32 s20, s20, s16
    s_add_u32 s20, s20, 0xe00000
    s_lshl_b32 s22, s8, 20
    s_add_u32 s22, s22, s16
    s_add_u32 s22, s22, 0x5000000
    s_mov_b32 s21, 131072
    s_mov_b32 s23, 131072
    s_lshl_b32 s25, s11, 22
    s_lshl_b32 s16, s8, 18
    s_add_u32 s25, s25, s16
    s_lshl_b32 s16, s10, 9
    s_add_u32 s25, s25, s16
    s_add_u32 s25, s25, 0x6000000
    v_lshlrev_b32 v4, 4, v1
    s_mul_i32 s6, s4, 4
    s_mul_i32 s6, s6, s21
    s_add_u32 s6, s6, s20
    s_mul_i32 s7, s5, 4
    s_mul_i32 s7, s7, s23
    s_add_u32 s7, s7, s22
    v_add_u32 v8, s6, v4
    s_add_u32 s6, s6, s21
    v_add_u32 v9, s6, v4
    s_add_u32 s6, s6, s21
    v_add_u32 v10, s6, v4
    s_add_u32 s6, s6, s21
    v_add_u32 v11, s6, v4
    s_add_u32 s6, s6, s21
    v_add_u32 v12, s7, v4
    s_add_u32 s7, s7, s23
    v_add_u32 v13, s7, v4
    s_add_u32 s7, s7, s23
    v_add_u32 v14, s7, v4
    s_add_u32 s7, s7, s23
    v_add_u32 v15, s7, v4
    s_add_u32 s7, s7, s23
    v_mov_b32 v144, 0
    v_mov_b32 v145, 0
    v_mov_b32 v146, 0
    v_mov_b32 v147, 0
    v_mov_b32 v148, 0
    v_mov_b32 v149, 0
    v_mov_b32 v150, 0
    v_mov_b32 v151, 0
    v_mov_b32 v152, 0
    v_mov_b32 v153, 0
    v_mov_b32 v154, 0
    v_mov_b32 v155, 0
    v_mov_b32 v156, 0
    v_mov_b32 v157, 0
    v_mov_b32 v158, 0
    v_mov_b32 v159, 0
    v_mov_b32 v160, 0
    v_mov_b32 v161, 0
    v_mov_b32 v162, 0
    v_mov_b32 v163, 0
    v_mov_b32 v164, 0
    v_mov_b32 v165, 0
    v_mov_b32 v166, 0
    v_mov_b32 v167, 0
    v_mov_b32 v168, 0
    v_mov_b32 v169, 0
    v_mov_b32 v170, 0
    v_mov_b32 v171, 0
    v_mov_b32 v172, 0
    v_mov_b32 v173, 0
    v_mov_b32 v174, 0
    v_mov_b32 v175, 0
    v_mov_b32 v176, 0
    v_mov_b32 v177, 0
    v_mov_b32 v178, 0
    v_mov_b32 v179, 0
    v_mov_b32 v180, 0
    v_mov_b32 v181, 0
    v_mov_b32 v182, 0
    v_mov_b32 v183, 0
    v_mov_b32 v184, 0
    v_mov_b32 v185, 0
    v_mov_b32 v186, 0
    v_mov_b32 v187, 0
    v_mov_b32 v188, 0
    v_mov_b32 v189, 0
    v_mov_b32 v190, 0
    v_mov_b32 v191, 0
    v_mov_b32 v192, 0
    v_mov_b32 v193, 0
    v_mov_b32 v194, 0
    v_mov_b32 v195, 0
    v_mov_b32 v196, 0
    v_mov_b32 v197, 0
    v_mov_b32 v198, 0
    v_mov_b32 v199, 0
    v_mov_b32 v200, 0
    v_mov_b32 v201, 0
    v_mov_b32 v202, 0
    v_mov_b32 v203, 0
    v_mov_b32 v204, 0
    v_mov_b32 v205, 0
    v_mov_b32 v206, 0
    v_mov_b32 v207, 0
    s_mov_b32 s24, 0
    buffer_load_dwordx4 v[16:19], v8, s[12:15], s24 offen
    buffer_load_dwordx4 v[20:23], v9, s[12:15], s24 offen
    buffer_load_dwordx4 v[24:27], v10, s[12:15], s24 offen
    buffer_load_dwordx4 v[28:31], v11, s[12:15], s24 offen
    buffer_load_dwordx4 v[32:35], v12, s[12:15], s24 offen
    buffer_load_dwordx4 v[36:39], v13, s[12:15], s24 offen
    buffer_load_dwordx4 v[40:43], v14, s[12:15], s24 offen
    buffer_load_dwordx4 v[44:47], v15, s[12:15], s24 offen
    buffer_load_dwordx4 v[48:51], v8, s[12:15], s24 offen offset:1024
    buffer_load_dwordx4 v[52:55], v9, s[12:15], s24 offen offset:1024
    buffer_load_dwordx4 v[56:59], v10, s[12:15], s24 offen offset:1024
    buffer_load_dwordx4 v[60:63], v11, s[12:15], s24 offen offset:1024
    buffer_load_dwordx4 v[64:67], v12, s[12:15], s24 offen offset:1024
    buffer_load_dwordx4 v[68:71], v13, s[12:15], s24 offen offset:1024
    buffer_load_dwordx4 v[72:75], v14, s[12:15], s24 offen offset:1024
    buffer_load_dwordx4 v[76:79], v15, s[12:15], s24 offen offset:1024
    buffer_load_dwordx4 v[80:83], v8, s[12:15], s24 offen offset:2048
    buffer_load_dwordx4 v[84:87], v9, s[12:15], s24 offen offset:2048
    buffer_load_dwordx4 v[88:91], v10, s[12:15], s24 offen offset:2048
    buffer_load_dwordx4 v[92:95], v11, s[12:15], s24 offen offset:2048
    buffer_load_dwordx4 v[96:99], v12, s[12:15], s24 offen offset:2048
    buffer_load_dwordx4 v[100:103], v13, s[12:15], s24 offen offset:2048
    buffer_load_dwordx4 v[104:107], v14, s[12:15], s24 offen offset:2048
    buffer_load_dwordx4 v[108:111], v15, s[12:15], s24 offen offset:2048
wo_kernel_loop:
    buffer_load_dwordx4 v[112:115], v8, s[12:15], s24 offen offset:3072
    buffer_load_dwordx4 v[116:119], v9, s[12:15], s24 offen offset:3072
    buffer_load_dwordx4 v[120:123], v10, s[12:15], s24 offen offset:3072
    buffer_load_dwordx4 v[124:127], v11, s[12:15], s24 offen offset:3072
    buffer_load_dwordx4 v[128:131], v12, s[12:15], s24 offen offset:3072
    buffer_load_dwordx4 v[132:135], v13, s[12:15], s24 offen offset:3072
    buffer_load_dwordx4 v[136:139], v14, s[12:15], s24 offen offset:3072
    buffer_load_dwordx4 v[140:143], v15, s[12:15], s24 offen offset:3072
    s_add_u32 s24, s24, 4096
    s_waitcnt vmcnt(24)
    v_mfma_f32_16x16x32_bf16 v[144:147], v[16:19], v[32:35], v[144:147]
    v_mfma_f32_16x16x32_bf16 v[148:151], v[16:19], v[36:39], v[148:151]
    v_mfma_f32_16x16x32_bf16 v[152:155], v[16:19], v[40:43], v[152:155]
    v_mfma_f32_16x16x32_bf16 v[156:159], v[16:19], v[44:47], v[156:159]
    v_mfma_f32_16x16x32_bf16 v[160:163], v[20:23], v[32:35], v[160:163]
    v_mfma_f32_16x16x32_bf16 v[164:167], v[20:23], v[36:39], v[164:167]
    v_mfma_f32_16x16x32_bf16 v[168:171], v[20:23], v[40:43], v[168:171]
    v_mfma_f32_16x16x32_bf16 v[172:175], v[20:23], v[44:47], v[172:175]
    v_mfma_f32_16x16x32_bf16 v[176:179], v[24:27], v[32:35], v[176:179]
    v_mfma_f32_16x16x32_bf16 v[180:183], v[24:27], v[36:39], v[180:183]
    v_mfma_f32_16x16x32_bf16 v[184:187], v[24:27], v[40:43], v[184:187]
    v_mfma_f32_16x16x32_bf16 v[188:191], v[24:27], v[44:47], v[188:191]
    v_mfma_f32_16x16x32_bf16 v[192:195], v[28:31], v[32:35], v[192:195]
    v_mfma_f32_16x16x32_bf16 v[196:199], v[28:31], v[36:39], v[196:199]
    v_mfma_f32_16x16x32_bf16 v[200:203], v[28:31], v[40:43], v[200:203]
    v_mfma_f32_16x16x32_bf16 v[204:207], v[28:31], v[44:47], v[204:207]
    buffer_load_dwordx4 v[16:19], v8, s[12:15], s24 offen
    buffer_load_dwordx4 v[20:23], v9, s[12:15], s24 offen
    buffer_load_dwordx4 v[24:27], v10, s[12:15], s24 offen
    buffer_load_dwordx4 v[28:31], v11, s[12:15], s24 offen
    buffer_load_dwordx4 v[32:35], v12, s[12:15], s24 offen
    buffer_load_dwordx4 v[36:39], v13, s[12:15], s24 offen
    buffer_load_dwordx4 v[40:43], v14, s[12:15], s24 offen
    buffer_load_dwordx4 v[44:47], v15, s[12:15], s24 offen
    s_waitcnt vmcnt(24)
    v_mfma_f32_16x16x32_bf16 v[144:147], v[48:51], v[64:67], v[144:147]
    v_mfma_f32_16x16x32_bf16 v[148:151], v[48:51], v[68:71], v[148:151]
    v_mfma_f32_16x16x32_bf16 v[152:155], v[48:51], v[72:75], v[152:155]
    v_mfma_f32_16x16x32_bf16 v[156:159], v[48:51], v[76:79], v[156:159]
    v_mfma_f32_16x16x32_bf16 v[160:163], v[52:55], v[64:67], v[160:163]
    v_mfma_f32_16x16x32_bf16 v[164:167], v[52:55], v[68:71], v[164:167]
    v_mfma_f32_16x16x32_bf16 v[168:171], v[52:55], v[72:75], v[168:171]
    v_mfma_f32_16x16x32_bf16 v[172:175], v[52:55], v[76:79], v[172:175]
    v_mfma_f32_16x16x32_bf16 v[176:179], v[56:59], v[64:67], v[176:179]
    v_mfma_f32_16x16x32_bf16 v[180:183], v[56:59], v[68:71], v[180:183]
    v_mfma_f32_16x16x32_bf16 v[184:187], v[56:59], v[72:75], v[184:187]
    v_mfma_f32_16x16x32_bf16 v[188:191], v[56:59], v[76:79], v[188:191]
    v_mfma_f32_16x16x32_bf16 v[192:195], v[60:63], v[64:67], v[192:195]
    v_mfma_f32_16x16x32_bf16 v[196:199], v[60:63], v[68:71], v[196:199]
    v_mfma_f32_16x16x32_bf16 v[200:203], v[60:63], v[72:75], v[200:203]
    v_mfma_f32_16x16x32_bf16 v[204:207], v[60:63], v[76:79], v[204:207]
    buffer_load_dwordx4 v[48:51], v8, s[12:15], s24 offen offset:1024
    buffer_load_dwordx4 v[52:55], v9, s[12:15], s24 offen offset:1024
    buffer_load_dwordx4 v[56:59], v10, s[12:15], s24 offen offset:1024
    buffer_load_dwordx4 v[60:63], v11, s[12:15], s24 offen offset:1024
    buffer_load_dwordx4 v[64:67], v12, s[12:15], s24 offen offset:1024
    buffer_load_dwordx4 v[68:71], v13, s[12:15], s24 offen offset:1024
    buffer_load_dwordx4 v[72:75], v14, s[12:15], s24 offen offset:1024
    buffer_load_dwordx4 v[76:79], v15, s[12:15], s24 offen offset:1024
    s_waitcnt vmcnt(24)
    v_mfma_f32_16x16x32_bf16 v[144:147], v[80:83], v[96:99], v[144:147]
    v_mfma_f32_16x16x32_bf16 v[148:151], v[80:83], v[100:103], v[148:151]
    v_mfma_f32_16x16x32_bf16 v[152:155], v[80:83], v[104:107], v[152:155]
    v_mfma_f32_16x16x32_bf16 v[156:159], v[80:83], v[108:111], v[156:159]
    v_mfma_f32_16x16x32_bf16 v[160:163], v[84:87], v[96:99], v[160:163]
    v_mfma_f32_16x16x32_bf16 v[164:167], v[84:87], v[100:103], v[164:167]
    v_mfma_f32_16x16x32_bf16 v[168:171], v[84:87], v[104:107], v[168:171]
    v_mfma_f32_16x16x32_bf16 v[172:175], v[84:87], v[108:111], v[172:175]
    v_mfma_f32_16x16x32_bf16 v[176:179], v[88:91], v[96:99], v[176:179]
    v_mfma_f32_16x16x32_bf16 v[180:183], v[88:91], v[100:103], v[180:183]
    v_mfma_f32_16x16x32_bf16 v[184:187], v[88:91], v[104:107], v[184:187]
    v_mfma_f32_16x16x32_bf16 v[188:191], v[88:91], v[108:111], v[188:191]
    v_mfma_f32_16x16x32_bf16 v[192:195], v[92:95], v[96:99], v[192:195]
    v_mfma_f32_16x16x32_bf16 v[196:199], v[92:95], v[100:103], v[196:199]
    v_mfma_f32_16x16x32_bf16 v[200:203], v[92:95], v[104:107], v[200:203]
    v_mfma_f32_16x16x32_bf16 v[204:207], v[92:95], v[108:111], v[204:207]
    buffer_load_dwordx4 v[80:83], v8, s[12:15], s24 offen offset:2048
    buffer_load_dwordx4 v[84:87], v9, s[12:15], s24 offen offset:2048
    buffer_load_dwordx4 v[88:91], v10, s[12:15], s24 offen offset:2048
    buffer_load_dwordx4 v[92:95], v11, s[12:15], s24 offen offset:2048
    buffer_load_dwordx4 v[96:99], v12, s[12:15], s24 offen offset:2048
    buffer_load_dwordx4 v[100:103], v13, s[12:15], s24 offen offset:2048
    buffer_load_dwordx4 v[104:107], v14, s[12:15], s24 offen offset:2048
    buffer_load_dwordx4 v[108:111], v15, s[12:15], s24 offen offset:2048
    s_waitcnt vmcnt(24)
    v_mfma_f32_16x16x32_bf16 v[144:147], v[112:115], v[128:131], v[144:147]
    v_mfma_f32_16x16x32_bf16 v[148:151], v[112:115], v[132:135], v[148:151]
    v_mfma_f32_16x16x32_bf16 v[152:155], v[112:115], v[136:139], v[152:155]
    v_mfma_f32_16x16x32_bf16 v[156:159], v[112:115], v[140:143], v[156:159]
    v_mfma_f32_16x16x32_bf16 v[160:163], v[116:119], v[128:131], v[160:163]
    v_mfma_f32_16x16x32_bf16 v[164:167], v[116:119], v[132:135], v[164:167]
    v_mfma_f32_16x16x32_bf16 v[168:171], v[116:119], v[136:139], v[168:171]
    v_mfma_f32_16x16x32_bf16 v[172:175], v[116:119], v[140:143], v[172:175]
    v_mfma_f32_16x16x32_bf16 v[176:179], v[120:123], v[128:131], v[176:179]
    v_mfma_f32_16x16x32_bf16 v[180:183], v[120:123], v[132:135], v[180:183]
    v_mfma_f32_16x16x32_bf16 v[184:187], v[120:123], v[136:139], v[184:187]
    v_mfma_f32_16x16x32_bf16 v[188:191], v[120:123], v[140:143], v[188:191]
    v_mfma_f32_16x16x32_bf16 v[192:195], v[124:127], v[128:131], v[192:195]
    v_mfma_f32_16x16x32_bf16 v[196:199], v[124:127], v[132:135], v[196:199]
    v_mfma_f32_16x16x32_bf16 v[200:203], v[124:127], v[136:139], v[200:203]
    v_mfma_f32_16x16x32_bf16 v[204:207], v[124:127], v[140:143], v[204:207]
    s_cmp_lt_u32 s24, 32768
    s_cbranch_scc1 wo_kernel_loop
    s_waitcnt vmcnt(0)
    s_nop 7
    s_nop 7
    s_lshl_b32 s6, s5, 6
    v_add_u32 v208, s6, v3
    v_lshlrev_b32 v208, 11, v208
    s_lshl_b32 s6, s4, 6
    v_lshl_add_u32 v209, v2, 2, s6
    v_lshl_add_u32 v208, v209, 2, v208
    buffer_store_dwordx4 v[144:147], v208, s[12:15], s25 offen offset:0
    buffer_store_dwordx4 v[160:163], v208, s[12:15], s25 offen offset:64
    buffer_store_dwordx4 v[176:179], v208, s[12:15], s25 offen offset:128
    buffer_store_dwordx4 v[192:195], v208, s[12:15], s25 offen offset:192
    s_add_u32 s25, s25, 32768
    buffer_store_dwordx4 v[148:151], v208, s[12:15], s25 offen offset:0
    buffer_store_dwordx4 v[164:167], v208, s[12:15], s25 offen offset:64
    buffer_store_dwordx4 v[180:183], v208, s[12:15], s25 offen offset:128
    buffer_store_dwordx4 v[196:199], v208, s[12:15], s25 offen offset:192
    s_add_u32 s25, s25, 32768
    buffer_store_dwordx4 v[152:155], v208, s[12:15], s25 offen offset:0
    buffer_store_dwordx4 v[168:171], v208, s[12:15], s25 offen offset:64
    buffer_store_dwordx4 v[184:187], v208, s[12:15], s25 offen offset:128
    buffer_store_dwordx4 v[200:203], v208, s[12:15], s25 offen offset:192
    s_add_u32 s25, s25, 32768
    buffer_store_dwordx4 v[156:159], v208, s[12:15], s25 offen offset:0
    buffer_store_dwordx4 v[172:175], v208, s[12:15], s25 offen offset:64
    buffer_store_dwordx4 v[188:191], v208, s[12:15], s25 offen offset:128
    buffer_store_dwordx4 v[204:207], v208, s[12:15], s25 offen offset:192
    s_add_u32 s25, s25, 32768
wo_kernel_end:
    s_endpgm
.globl ln2_kernel
.p2align 8
.type ln2_kernel,@function
ln2_kernel:
    s_load_dwordx2 s[38:39], s[0:1], 104
    s_load_dwordx2 s[20:21], s[0:1], 0
    s_cmp_ge_u32 s2, 512
    s_cbranch_scc1 ln2_end
    v_and_b32 v1, 63, v0
    v_lshrrev_b32 v2, 4, v1
    v_and_b32 v3, 15, v1
    v_lshrrev_b32 v4, 6, v0
    s_nop 0
    v_readfirstlane_b32 s3, v4
    s_waitcnt lgkmcnt(0)
    s_mov_b32 s12, s38
    s_mov_b32 s13, s39
    s_mov_b32 s14, 0x10000000
    s_mov_b32 s15, 0x20000
    s_mov_b32 s8, s20
    s_mov_b32 s9, s21
    s_mov_b32 s10, 0x200000
    s_mov_b32 s11, 0x20000
    s_lshl_b32 s4, s2, 2
    s_add_u32 s4, s4, s3
    s_lshl_b32 s5, s4, 10
    v_lshlrev_b32 v6, 4, v1
    buffer_load_dwordx4 v[8:11], v6, s[8:11], s5 offen
    v_lshlrev_b32 v7, 5, v1
    s_lshl_b32 s6, s4, 11
    s_add_u32 s6, s6, 0x6000000
    v_xor_b32 v5, 32, v1
    v_lshlrev_b32 v5, 2, v5
    buffer_load_dwordx4 v[32:35], v7, s[12:15], s6 offen
    buffer_load_dwordx4 v[36:39], v7, s[12:15], s6 offen offset:16
    s_add_u32 s6, s6, 0x400000
    buffer_load_dwordx4 v[40:43], v7, s[12:15], s6 offen
    buffer_load_dwordx4 v[44:47], v7, s[12:15], s6 offen offset:16
    s_add_u32 s6, s6, 0x400000
    buffer_load_dwordx4 v[48:51], v7, s[12:15], s6 offen
    buffer_load_dwordx4 v[52:55], v7, s[12:15], s6 offen offset:16
    s_add_u32 s6, s6, 0x400000
    buffer_load_dwordx4 v[56:59], v7, s[12:15], s6 offen
    buffer_load_dwordx4 v[60:63], v7, s[12:15], s6 offen offset:16
    s_add_u32 s6, s6, 0x400000
    s_waitcnt vmcnt(0)
    v_add_f32 v32, v32, v40
    v_add_f32 v32, v32, v48
    v_add_f32 v32, v32, v56
    v_cvt_pk_bf16_f32 v24, v32, v32
    v_lshlrev_b32 v32, 16, v24
    v_lshlrev_b32 v25, 16, v8
    v_add_f32 v16, v32, v25
    v_add_f32 v33, v33, v41
    v_add_f32 v33, v33, v49
    v_add_f32 v33, v33, v57
    v_cvt_pk_bf16_f32 v24, v33, v33
    v_lshlrev_b32 v33, 16, v24
    v_and_b32 v25, 0xffff0000, v8
    v_add_f32 v17, v33, v25
    v_add_f32 v34, v34, v42
    v_add_f32 v34, v34, v50
    v_add_f32 v34, v34, v58
    v_cvt_pk_bf16_f32 v24, v34, v34
    v_lshlrev_b32 v34, 16, v24
    v_lshlrev_b32 v25, 16, v9
    v_add_f32 v18, v34, v25
    v_add_f32 v35, v35, v43
    v_add_f32 v35, v35, v51
    v_add_f32 v35, v35, v59
    v_cvt_pk_bf16_f32 v24, v35, v35
    v_lshlrev_b32 v35, 16, v24
    v_and_b32 v25, 0xffff0000, v9
    v_add_f32 v19, v35, v25
    v_add_f32 v36, v36, v44
    v_add_f32 v36, v36, v52
    v_add_f32 v36, v36, v60
    v_cvt_pk_bf16_f32 v24, v36, v36
    v_lshlrev_b32 v36, 16, v24
    v_lshlrev_b32 v25, 16, v10
    v_add_f32 v20, v36, v25
    v_add_f32 v37, v37, v45
    v_add_f32 v37, v37, v53
    v_add_f32 v37, v37, v61
    v_cvt_pk_bf16_f32 v24, v37, v37
    v_lshlrev_b32 v37, 16, v24
    v_and_b32 v25, 0xffff0000, v10
    v_add_f32 v21, v37, v25
    v_add_f32 v38, v38, v46
    v_add_f32 v38, v38, v54
    v_add_f32 v38, v38, v62
    v_cvt_pk_bf16_f32 v24, v38, v38
    v_lshlrev_b32 v38, 16, v24
    v_lshlrev_b32 v25, 16, v11
    v_add_f32 v22, v38, v25
    v_add_f32 v39, v39, v47
    v_add_f32 v39, v39, v55
    v_add_f32 v39, v39, v63
    v_cvt_pk_bf16_f32 v24, v39, v39
    v_lshlrev_b32 v39, 16, v24
    v_and_b32 v25, 0xffff0000, v11
    v_add_f32 v23, v39, v25
    v_cvt_pk_bf16_f32 v8, v16, v17
    v_cvt_pk_bf16_f32 v9, v18, v19
    v_cvt_pk_bf16_f32 v10, v20, v21
    v_cvt_pk_bf16_f32 v11, v22, v23
    s_add_u32 s7, s5, 0x7000000
    buffer_store_dwordx4 v[8:11], v6, s[12:15], s7 offen
    s_nop 1
    v_mov_b32 v12, v8
    v_mov_b32 v13, v9
    v_mov_b32 v14, v10
    v_mov_b32 v15, v11
    v_lshlrev_b32 v16, 16, v12
    v_and_b32 v17, 0xffff0000, v12
    v_lshlrev_b32 v18, 16, v13
    v_and_b32 v19, 0xffff0000, v13
    v_lshlrev_b32 v20, 16, v14
    v_and_b32 v21, 0xffff0000, v14
    v_lshlrev_b32 v22, 16, v15
    v_and_b32 v23, 0xffff0000, v15
    v_add_f32 v24, v16, v17
    v_add_f32 v24, v24, v18
    v_add_f32 v24, v24, v19
    v_add_f32 v24, v24, v20
    v_add_f32 v24, v24, v21
    v_add_f32 v24, v24, v22
    v_add_f32 v24, v24, v23
    ds_swizzle_b32 v27, v24 offset:0x41f
    s_waitcnt lgkmcnt(0)
    v_add_f32 v24, v24, v27
    ds_swizzle_b32 v27, v24 offset:0x81f
    s_waitcnt lgkmcnt(0)
    v_add_f32 v24, v24, v27
    ds_swizzle_b32 v27, v24 offset:0x101f
    s_waitcnt lgkmcnt(0)
    v_add_f32 v24, v24, v27
    ds_swizzle_b32 v27, v24 offset:0x201f
    s_waitcnt lgkmcnt(0)
    v_add_f32 v24, v24, v27
    ds_swizzle_b32 v27, v24 offset:0x401f
    s_waitcnt lgkmcnt(0)
    v_add_f32 v24, v24, v27
    ds_bpermute_b32 v27, v5, v24
    s_waitcnt lgkmcnt(0)
    v_add_f32 v24, v24, v27
    v_mul_f32 v26, 0x3b000000, v24
    v_sub_f32 v27, v16, v26
    v_mul_f32 v25, v27, v27
    v_sub_f32 v27, v17, v26
    v_fmac_f32 v25, v27, v27
    v_sub_f32 v27, v18, v26
    v_fmac_f32 v25, v27, v27
    v_sub_f32 v27, v19, v26
    v_fmac_f32 v25, v27, v27
    v_sub_f32 v27, v20, v26
    v_fmac_f32 v25, v27, v27
    v_sub_f32 v27, v21, v26
    v_fmac_f32 v25, v27, v27
    v_sub_f32 v27, v22, v26
    v_fmac_f32 v25, v27, v27
    v_sub_f32 v27, v23, v26
    v_fmac_f32 v25, v27, v27
    ds_swizzle_b32 v27, v25 offset:0x41f
    s_waitcnt lgkmcnt(0)
    v_add_f32 v25, v25, v27
    ds_swizzle_b32 v27, v25 offset:0x81f
    s_waitcnt lgkmcnt(0)
    v_add_f32 v25, v25, v27
    ds_swizzle_b32 v27, v25 offset:0x101f
    s_waitcnt lgkmcnt(0)
    v_add_f32 v25, v25, v27
    ds_swizzle_b32 v27, v25 offset:0x201f
    s_waitcnt lgkmcnt(0)
    v_add_f32 v25, v25, v27
    ds_swizzle_b32 v27, v25 offset:0x401f
    s_waitcnt lgkmcnt(0)
    v_add_f32 v25, v25, v27
    ds_bpermute_b32 v27, v5, v25
    s_waitcnt lgkmcnt(0)
    v_add_f32 v25, v25, v27
    v_mul_f32 v25, 0x3b000000, v25
    v_cvt_pk_bf16_f32 v27, v26, v26
    v_lshlrev_b32 v26, 16, v27
    v_cvt_pk_bf16_f32 v27, v25, v25
    v_lshlrev_b32 v25, 16, v27
    v_add_f32 v25, 0x3727c5ac, v25
    v_cvt_pk_bf16_f32 v27, v25, v25
    v_lshlrev_b32 v25, 16, v27
    v_sqrt_f32 v25, v25
    s_nop 1
    v_cvt_pk_bf16_f32 v27, v25, v25
    v_lshlrev_b32 v25, 16, v27
    v_rcp_f32 v25, v25
    s_nop 1
    v_sub_f32 v16, v16, v26
    v_sub_f32 v17, v17, v26
    v_sub_f32 v18, v18, v26
    v_sub_f32 v19, v19, v26
    v_sub_f32 v20, v20, v26
    v_sub_f32 v21, v21, v26
    v_sub_f32 v22, v22, v26
    v_sub_f32 v23, v23, v26
    v_cvt_pk_bf16_f32 v27, v16, v17
    v_lshlrev_b32 v16, 16, v27
    v_and_b32 v17, 0xffff0000, v27
    v_mul_f32 v16, v16, v25
    v_mul_f32 v17, v17, v25
    v_cvt_pk_bf16_f32 v27, v18, v19
    v_lshlrev_b32 v18, 16, v27
    v_and_b32 v19, 0xffff0000, v27
    v_mul_f32 v18, v18, v25
    v_mul_f32 v19, v19, v25
    v_cvt_pk_bf16_f32 v27, v20, v21
    v_lshlrev_b32 v20, 16, v27
    v_and_b32 v21, 0xffff0000, v27
    v_mul_f32 v20, v20, v25
    v_mul_f32 v21, v21, v25
    v_cvt_pk_bf16_f32 v27, v22, v23
    v_lshlrev_b32 v22, 16, v27
    v_and_b32 v23, 0xffff0000, v27
    v_mul_f32 v22, v22, v25
    v_mul_f32 v23, v23, v25
    v_cvt_pk_bf16_f32 v12, v16, v17
    v_cvt_pk_bf16_f32 v13, v18, v19
    v_cvt_pk_bf16_f32 v14, v20, v21
    v_cvt_pk_bf16_f32 v15, v22, v23
    s_lshr_b32 s5, s4, 4
    s_lshl_b32 s5, s5, 14
    s_and_b32 s6, s4, 15
    s_lshl_b32 s6, s6, 4
    s_add_u32 s5, s5, s6
    s_add_u32 s5, s5, 0x7200000
    v_lshrrev_b32 v6, 2, v1
    v_lshlrev_b32 v6, 10, v6
    v_and_b32 v7, 3, v1
    v_lshl_add_u32 v6, v7, 8, v6
    buffer_store_dwordx4 v[12:15], v6, s[12:15], s5 offen
ln2_end:
    s_endpgm
.globl gu_kernel
.p2align 8
.type gu_kernel,@function
gu_kernel:
    s_load_dwordx2 s[38:39], s[0:1], 104
    s_load_dwordx2 s[36:37], s[0:1], 88
    s_cmp_ge_u32 s2, 448
    s_cbranch_scc1 gu_kernel_end
    v_and_b32 v1, 63, v0
    v_lshrrev_b32 v2, 4, v1
    v_and_b32 v3, 15, v1
    v_lshrrev_b32 v4, 6, v0
    s_nop 0
    v_readfirstlane_b32 s3, v4
    s_waitcnt lgkmcnt(0)
    s_mov_b32 s12, s38
    s_mov_b32 s13, s39
    s_mov_b32 s14, 0x10000000
    s_mov_b32 s15, 0x20000
    s_lshr_b32 s4, s3, 1
    s_and_b32 s5, s3, 1
    s_and_b32 s8, s2, 15
    s_lshr_b32 s9, s2, 4
    s_lshl_b32 s20, s9, 17
    s_add_u32 s20, s20, 0x1200000
    s_lshl_b32 s22, s8, 17
    s_add_u32 s22, s22, 0x7200000
    s_mov_b32 s21, 16384
    s_mov_b32 s23, 16384
    s_lshl_b32 s16, s8, 3
    s_lshl_b32 s17, s5, 2
    s_add_u32 s16, s16, s17
    s_mul_i32 s16, s16, 56
    s_lshl_b32 s17, s9, 1
    s_add_u32 s17, s17, s4
    s_add_u32 s16, s16, s17
    s_lshl_b32 s25, s16, 10
    s_add_u32 s25, s25, 0x7400000
    v_lshlrev_b32 v4, 4, v1
    s_mul_i32 s6, s4, 4
    s_mul_i32 s6, s6, s21
    s_add_u32 s6, s6, s20
    s_mul_i32 s7, s5, 4
    s_mul_i32 s7, s7, s23
    s_add_u32 s7, s7, s22
    v_add_u32 v8, s6, v4
    s_add_u32 s6, s6, s21
    v_add_u32 v9, s6, v4
    s_add_u32 s6, s6, s21
    v_add_u32 v10, s6, v4
    s_add_u32 s6, s6, s21
    v_add_u32 v11, s6, v4
    s_add_u32 s6, s6, s21
    v_add_u32 v12, s7, v4
    s_add_u32 s7, s7, s23
    v_add_u32 v13, s7, v4
    s_add_u32 s7, s7, s23
    v_add_u32 v14, s7, v4
    s_add_u32 s7, s7, s23
    v_add_u32 v15, s7, v4
    s_add_u32 s7, s7, s23
    v_mov_b32 v144, 0
    v_mov_b32 v145, 0
    v_mov_b32 v146, 0
    v_mov_b32 v147, 0
    v_mov_b32 v148, 0
    v_mov_b32 v149, 0
    v_mov_b32 v150, 0
    v_mov_b32 v151, 0
    v_mov_b32 v152, 0
    v_mov_b32 v153, 0
    v_mov_b32 v154, 0
    v_mov_b32 v155, 0
    v_mov_b32 v156, 0
    v_mov_b32 v157, 0
    v_mov_b32 v158, 0
    v_mov_b32 v159, 0
    v_mov_b32 v160, 0
    v_mov_b32 v161, 0
    v_mov_b32 v162, 0
    v_mov_b32 v163, 0
    v_mov_b32 v164, 0
    v_mov_b32 v165, 0
    v_mov_b32 v166, 0
    v_mov_b32 v167, 0
    v_mov_b32 v168, 0
    v_mov_b32 v169, 0
    v_mov_b32 v170, 0
    v_mov_b32 v171, 0
    v_mov_b32 v172, 0
    v_mov_b32 v173, 0
    v_mov_b32 v174, 0
    v_mov_b32 v175, 0
    v_mov_b32 v176, 0
    v_mov_b32 v177, 0
    v_mov_b32 v178, 0
    v_mov_b32 v179, 0
    v_mov_b32 v180, 0
    v_mov_b32 v181, 0
    v_mov_b32 v182, 0
    v_mov_b32 v183, 0
    v_mov_b32 v184, 0
    v_mov_b32 v185, 0
    v_mov_b32 v186, 0
    v_mov_b32 v187, 0
    v_mov_b32 v188, 0
    v_mov_b32 v189, 0
    v_mov_b32 v190, 0
    v_mov_b32 v191, 0
    v_mov_b32 v192, 0
    v_mov_b32 v193, 0
    v_mov_b32 v194, 0
    v_mov_b32 v195, 0
    v_mov_b32 v196, 0
    v_mov_b32 v197, 0
    v_mov_b32 v198, 0
    v_mov_b32 v199, 0
    v_mov_b32 v200, 0
    v_mov_b32 v201, 0
    v_mov_b32 v202, 0
    v_mov_b32 v203, 0
    v_mov_b32 v204, 0
    v_mov_b32 v205, 0
    v_mov_b32 v206, 0
    v_mov_b32 v207, 0
    s_mov_b32 s24, 0
    buffer_load_dwordx4 v[16:19], v8, s[12:15], s24 offen
    buffer_load_dwordx4 v[20:23], v9, s[12:15], s24 offen
    buffer_load_dwordx4 v[24:27], v10, s[12:15], s24 offen
    buffer_load_dwordx4 v[28:31], v11, s[12:15], s24 offen
    buffer_load_dwordx4 v[32:35], v12, s[12:15], s24 offen
    buffer_load_dwordx4 v[36:39], v13, s[12:15], s24 offen
    buffer_load_dwordx4 v[40:43], v14, s[12:15], s24 offen
    buffer_load_dwordx4 v[44:47], v15, s[12:15], s24 offen
    buffer_load_dwordx4 v[48:51], v8, s[12:15], s24 offen offset:1024
    buffer_load_dwordx4 v[52:55], v9, s[12:15], s24 offen offset:1024
    buffer_load_dwordx4 v[56:59], v10, s[12:15], s24 offen offset:1024
    buffer_load_dwordx4 v[60:63], v11, s[12:15], s24 offen offset:1024
    buffer_load_dwordx4 v[64:67], v12, s[12:15], s24 offen offset:1024
    buffer_load_dwordx4 v[68:71], v13, s[12:15], s24 offen offset:1024
    buffer_load_dwordx4 v[72:75], v14, s[12:15], s24 offen offset:1024
    buffer_load_dwordx4 v[76:79], v15, s[12:15], s24 offen offset:1024
    buffer_load_dwordx4 v[80:83], v8, s[12:15], s24 offen offset:2048
    buffer_load_dwordx4 v[84:87], v9, s[12:15], s24 offen offset:2048
    buffer_load_dwordx4 v[88:91], v10, s[12:15], s24 offen offset:2048
    buffer_load_dwordx4 v[92:95], v11, s[12:15], s24 offen offset:2048
    buffer_load_dwordx4 v[96:99], v12, s[12:15], s24 offen offset:2048
    buffer_load_dwordx4 v[100:103], v13, s[12:15], s24 offen offset:2048
    buffer_load_dwordx4 v[104:107], v14, s[12:15], s24 offen offset:2048
    buffer_load_dwordx4 v[108:111], v15, s[12:15], s24 offen offset:2048
gu_kernel_loop:
    buffer_load_dwordx4 v[112:115], v8, s[12:15], s24 offen offset:3072
    buffer_load_dwordx4 v[116:119], v9, s[12:15], s24 offen offset:3072
    buffer_load_dwordx4 v[120:123], v10, s[12:15], s24 offen offset:3072
    buffer_load_dwordx4 v[124:127], v11, s[12:15], s24 offen offset:3072
    buffer_load_dwordx4 v[128:131], v12, s[12:15], s24 offen offset:3072
    buffer_load_dwordx4 v[132:135], v13, s[12:15], s24 offen offset:3072
    buffer_load_dwordx4 v[136:139], v14, s[12:15], s24 offen offset:3072
    buffer_load_dwordx4 v[140:143], v15, s[12:15], s24 offen offset:3072
    s_add_u32 s24, s24, 4096
    s_waitcnt vmcnt(24)
    v_mfma_f32_16x16x32_bf16 v[144:147], v[16:19], v[32:35], v[144:147]
    v_mfma_f32_16x16x32_bf16 v[148:151], v[16:19], v[36:39], v[148:151]
    v_mfma_f32_16x16x32_bf16 v[152:155], v[16:19], v[40:43], v[152:155]
    v_mfma_f32_16x16x32_bf16 v[156:159], v[16:19], v[44:47], v[156:159]
    v_mfma_f32_16x16x32_bf16 v[160:163], v[20:23], v[32:35], v[160:163]
    v_mfma_f32_16x16x32_bf16 v[164:167], v[20:23], v[36:39], v[164:167]
    v_mfma_f32_16x16x32_bf16 v[168:171], v[20:23], v[40:43], v[168:171]
    v_mfma_f32_16x16x32_bf16 v[172:175], v[20:23], v[44:47], v[172:175]
    v_mfma_f32_16x16x32_bf16 v[176:179], v[24:27], v[32:35], v[176:179]
    v_mfma_f32_16x16x32_bf16 v[180:183], v[24:27], v[36:39], v[180:183]
    v_mfma_f32_16x16x32_bf16 v[184:187], v[24:27], v[40:43], v[184:187]
    v_mfma_f32_16x16x32_bf16 v[188:191], v[24:27], v[44:47], v[188:191]
    v_mfma_f32_16x16x32_bf16 v[192:195], v[28:31], v[32:35], v[192:195]
    v_mfma_f32_16x16x32_bf16 v[196:199], v[28:31], v[36:39], v[196:199]
    v_mfma_f32_16x16x32_bf16 v[200:203], v[28:31], v[40:43], v[200:203]
    v_mfma_f32_16x16x32_bf16 v[204:207], v[28:31], v[44:47], v[204:207]
    buffer_load_dwordx4 v[16:19], v8, s[12:15], s24 offen
    buffer_load_dwordx4 v[20:23], v9, s[12:15], s24 offen
    buffer_load_dwordx4 v[24:27], v10, s[12:15], s24 offen
    buffer_load_dwordx4 v[28:31], v11, s[12:15], s24 offen
    buffer_load_dwordx4 v[32:35], v12, s[12:15], s24 offen
    buffer_load_dwordx4 v[36:39], v13, s[12:15], s24 offen
    buffer_load_dwordx4 v[40:43], v14, s[12:15], s24 offen
    buffer_load_dwordx4 v[44:47], v15, s[12:15], s24 offen
    s_waitcnt vmcnt(24)
    v_mfma_f32_16x16x32_bf16 v[144:147], v[48:51], v[64:67], v[144:147]
    v_mfma_f32_16x16x32_bf16 v[148:151], v[48:51], v[68:71], v[148:151]
    v_mfma_f32_16x16x32_bf16 v[152:155], v[48:51], v[72:75], v[152:155]
    v_mfma_f32_16x16x32_bf16 v[156:159], v[48:51], v[76:79], v[156:159]
    v_mfma_f32_16x16x32_bf16 v[160:163], v[52:55], v[64:67], v[160:163]
    v_mfma_f32_16x16x32_bf16 v[164:167], v[52:55], v[68:71], v[164:167]
    v_mfma_f32_16x16x32_bf16 v[168:171], v[52:55], v[72:75], v[168:171]
    v_mfma_f32_16x16x32_bf16 v[172:175], v[52:55], v[76:79], v[172:175]
    v_mfma_f32_16x16x32_bf16 v[176:179], v[56:59], v[64:67], v[176:179]
    v_mfma_f32_16x16x32_bf16 v[180:183], v[56:59], v[68:71], v[180:183]
    v_mfma_f32_16x16x32_bf16 v[184:187], v[56:59], v[72:75], v[184:187]
    v_mfma_f32_16x16x32_bf16 v[188:191], v[56:59], v[76:79], v[188:191]
    v_mfma_f32_16x16x32_bf16 v[192:195], v[60:63], v[64:67], v[192:195]
    v_mfma_f32_16x16x32_bf16 v[196:199], v[60:63], v[68:71], v[196:199]
    v_mfma_f32_16x16x32_bf16 v[200:203], v[60:63], v[72:75], v[200:203]
    v_mfma_f32_16x16x32_bf16 v[204:207], v[60:63], v[76:79], v[204:207]
    buffer_load_dwordx4 v[48:51], v8, s[12:15], s24 offen offset:1024
    buffer_load_dwordx4 v[52:55], v9, s[12:15], s24 offen offset:1024
    buffer_load_dwordx4 v[56:59], v10, s[12:15], s24 offen offset:1024
    buffer_load_dwordx4 v[60:63], v11, s[12:15], s24 offen offset:1024
    buffer_load_dwordx4 v[64:67], v12, s[12:15], s24 offen offset:1024
    buffer_load_dwordx4 v[68:71], v13, s[12:15], s24 offen offset:1024
    buffer_load_dwordx4 v[72:75], v14, s[12:15], s24 offen offset:1024
    buffer_load_dwordx4 v[76:79], v15, s[12:15], s24 offen offset:1024
    s_waitcnt vmcnt(24)
    v_mfma_f32_16x16x32_bf16 v[144:147], v[80:83], v[96:99], v[144:147]
    v_mfma_f32_16x16x32_bf16 v[148:151], v[80:83], v[100:103], v[148:151]
    v_mfma_f32_16x16x32_bf16 v[152:155], v[80:83], v[104:107], v[152:155]
    v_mfma_f32_16x16x32_bf16 v[156:159], v[80:83], v[108:111], v[156:159]
    v_mfma_f32_16x16x32_bf16 v[160:163], v[84:87], v[96:99], v[160:163]
    v_mfma_f32_16x16x32_bf16 v[164:167], v[84:87], v[100:103], v[164:167]
    v_mfma_f32_16x16x32_bf16 v[168:171], v[84:87], v[104:107], v[168:171]
    v_mfma_f32_16x16x32_bf16 v[172:175], v[84:87], v[108:111], v[172:175]
    v_mfma_f32_16x16x32_bf16 v[176:179], v[88:91], v[96:99], v[176:179]
    v_mfma_f32_16x16x32_bf16 v[180:183], v[88:91], v[100:103], v[180:183]
    v_mfma_f32_16x16x32_bf16 v[184:187], v[88:91], v[104:107], v[184:187]
    v_mfma_f32_16x16x32_bf16 v[188:191], v[88:91], v[108:111], v[188:191]
    v_mfma_f32_16x16x32_bf16 v[192:195], v[92:95], v[96:99], v[192:195]
    v_mfma_f32_16x16x32_bf16 v[196:199], v[92:95], v[100:103], v[196:199]
    v_mfma_f32_16x16x32_bf16 v[200:203], v[92:95], v[104:107], v[200:203]
    v_mfma_f32_16x16x32_bf16 v[204:207], v[92:95], v[108:111], v[204:207]
    buffer_load_dwordx4 v[80:83], v8, s[12:15], s24 offen offset:2048
    buffer_load_dwordx4 v[84:87], v9, s[12:15], s24 offen offset:2048
    buffer_load_dwordx4 v[88:91], v10, s[12:15], s24 offen offset:2048
    buffer_load_dwordx4 v[92:95], v11, s[12:15], s24 offen offset:2048
    buffer_load_dwordx4 v[96:99], v12, s[12:15], s24 offen offset:2048
    buffer_load_dwordx4 v[100:103], v13, s[12:15], s24 offen offset:2048
    buffer_load_dwordx4 v[104:107], v14, s[12:15], s24 offen offset:2048
    buffer_load_dwordx4 v[108:111], v15, s[12:15], s24 offen offset:2048
    s_waitcnt vmcnt(24)
    v_mfma_f32_16x16x32_bf16 v[144:147], v[112:115], v[128:131], v[144:147]
    v_mfma_f32_16x16x32_bf16 v[148:151], v[112:115], v[132:135], v[148:151]
    v_mfma_f32_16x16x32_bf16 v[152:155], v[112:115], v[136:139], v[152:155]
    v_mfma_f32_16x16x32_bf16 v[156:159], v[112:115], v[140:143], v[156:159]
    v_mfma_f32_16x16x32_bf16 v[160:163], v[116:119], v[128:131], v[160:163]
    v_mfma_f32_16x16x32_bf16 v[164:167], v[116:119], v[132:135], v[164:167]
    v_mfma_f32_16x16x32_bf16 v[168:171], v[116:119], v[136:139], v[168:171]
    v_mfma_f32_16x16x32_bf16 v[172:175], v[116:119], v[140:143], v[172:175]
    v_mfma_f32_16x16x32_bf16 v[176:179], v[120:123], v[128:131], v[176:179]
    v_mfma_f32_16x16x32_bf16 v[180:183], v[120:123], v[132:135], v[180:183]
    v_mfma_f32_16x16x32_bf16 v[184:187], v[120:123], v[136:139], v[184:187]
    v_mfma_f32_16x16x32_bf16 v[188:191], v[120:123], v[140:143], v[188:191]
    v_mfma_f32_16x16x32_bf16 v[192:195], v[124:127], v[128:131], v[192:195]
    v_mfma_f32_16x16x32_bf16 v[196:199], v[124:127], v[132:135], v[196:199]
    v_mfma_f32_16x16x32_bf16 v[200:203], v[124:127], v[136:139], v[200:203]
    v_mfma_f32_16x16x32_bf16 v[204:207], v[124:127], v[140:143], v[204:207]
    s_cmp_lt_u32 s24, 16384
    s_cbranch_scc1 gu_kernel_loop
    s_waitcnt vmcnt(0)
    s_nop 7
    s_nop 7
    v_lshlrev_b32 v208, 4, v1
    v_cvt_pk_bf16_f32 v214, v144, v144
    v_lshlrev_b32 v144, 16, v214
    v_cvt_pk_bf16_f32 v214, v176, v176
    v_lshlrev_b32 v176, 16, v214
    v_mul_f32 v214, v144, v144
    v_mul_f32 v214, 0x3d372713, v214
    v_add_f32 v214, 1.0, v214
    v_mul_f32 v214, v214, v144
    v_mul_f32 v214, 0x40135761, v214
    v_min_f32 v214, 0x42fc0000, v214
    v_exp_f32 v215, v214
    s_nop 1
    v_add_f32 v215, 1.0, v215
    v_rcp_f32 v215, v215
    s_nop 1
    v_fma_f32 v215, v215, -1.0, 1.0
    v_mul_f32 v144, v144, v215
    v_cvt_pk_bf16_f32 v214, v144, v144
    v_lshlrev_b32 v144, 16, v214
    v_mul_f32 v144, v144, v176
    v_cvt_pk_bf16_f32 v214, v145, v145
    v_lshlrev_b32 v145, 16, v214
    v_cvt_pk_bf16_f32 v214, v177, v177
    v_lshlrev_b32 v177, 16, v214
    v_mul_f32 v214, v145, v145
    v_mul_f32 v214, 0x3d372713, v214
    v_add_f32 v214, 1.0, v214
    v_mul_f32 v214, v214, v145
    v_mul_f32 v214, 0x40135761, v214
    v_min_f32 v214, 0x42fc0000, v214
    v_exp_f32 v215, v214
    s_nop 1
    v_add_f32 v215, 1.0, v215
    v_rcp_f32 v215, v215
    s_nop 1
    v_fma_f32 v215, v215, -1.0, 1.0
    v_mul_f32 v145, v145, v215
    v_cvt_pk_bf16_f32 v214, v145, v145
    v_lshlrev_b32 v145, 16, v214
    v_mul_f32 v145, v145, v177
    v_cvt_pk_bf16_f32 v214, v146, v146
    v_lshlrev_b32 v146, 16, v214
    v_cvt_pk_bf16_f32 v214, v178, v178
    v_lshlrev_b32 v178, 16, v214
    v_mul_f32 v214, v146, v146
    v_mul_f32 v214, 0x3d372713, v214
    v_add_f32 v214, 1.0, v214
    v_mul_f32 v214, v214, v146
    v_mul_f32 v214, 0x40135761, v214
    v_min_f32 v214, 0x42fc0000, v214
    v_exp_f32 v215, v214
    s_nop 1
    v_add_f32 v215, 1.0, v215
    v_rcp_f32 v215, v215
    s_nop 1
    v_fma_f32 v215, v215, -1.0, 1.0
    v_mul_f32 v146, v146, v215
    v_cvt_pk_bf16_f32 v214, v146, v146
    v_lshlrev_b32 v146, 16, v214
    v_mul_f32 v146, v146, v178
    v_cvt_pk_bf16_f32 v214, v147, v147
    v_lshlrev_b32 v147, 16, v214
    v_cvt_pk_bf16_f32 v214, v179, v179
    v_lshlrev_b32 v179, 16, v214
    v_mul_f32 v214, v147, v147
    v_mul_f32 v214, 0x3d372713, v214
    v_add_f32 v214, 1.0, v214
    v_mul_f32 v214, v214, v147
    v_mul_f32 v214, 0x40135761, v214
    v_min_f32 v214, 0x42fc0000, v214
    v_exp_f32 v215, v214
    s_nop 1
    v_add_f32 v215, 1.0, v215
    v_rcp_f32 v215, v215
    s_nop 1
    v_fma_f32 v215, v215, -1.0, 1.0
    v_mul_f32 v147, v147, v215
    v_cvt_pk_bf16_f32 v214, v147, v147
    v_lshlrev_b32 v147, 16, v214
    v_mul_f32 v147, v147, v179
    v_cvt_pk_bf16_f32 v214, v160, v160
    v_lshlrev_b32 v160, 16, v214
    v_cvt_pk_bf16_f32 v214, v192, v192
    v_lshlrev_b32 v192, 16, v214
    v_mul_f32 v214, v160, v160
    v_mul_f32 v214, 0x3d372713, v214
    v_add_f32 v214, 1.0, v214
    v_mul_f32 v214, v214, v160
    v_mul_f32 v214, 0x40135761, v214
    v_min_f32 v214, 0x42fc0000, v214
    v_exp_f32 v215, v214
    s_nop 1
    v_add_f32 v215, 1.0, v215
    v_rcp_f32 v215, v215
    s_nop 1
    v_fma_f32 v215, v215, -1.0, 1.0
    v_mul_f32 v160, v160, v215
    v_cvt_pk_bf16_f32 v214, v160, v160
    v_lshlrev_b32 v160, 16, v214
    v_mul_f32 v160, v160, v192
    v_cvt_pk_bf16_f32 v214, v161, v161
    v_lshlrev_b32 v161, 16, v214
    v_cvt_pk_bf16_f32 v214, v193, v193
    v_lshlrev_b32 v193, 16, v214
    v_mul_f32 v214, v161, v161
    v_mul_f32 v214, 0x3d372713, v214
    v_add_f32 v214, 1.0, v214
    v_mul_f32 v214, v214, v161
    v_mul_f32 v214, 0x40135761, v214
    v_min_f32 v214, 0x42fc0000, v214
    v_exp_f32 v215, v214
    s_nop 1
    v_add_f32 v215, 1.0, v215
    v_rcp_f32 v215, v215
    s_nop 1
    v_fma_f32 v215, v215, -1.0, 1.0
    v_mul_f32 v161, v161, v215
    v_cvt_pk_bf16_f32 v214, v161, v161
    v_lshlrev_b32 v161, 16, v214
    v_mul_f32 v161, v161, v193
    v_cvt_pk_bf16_f32 v214, v162, v162
    v_lshlrev_b32 v162, 16, v214
    v_cvt_pk_bf16_f32 v214, v194, v194
    v_lshlrev_b32 v194, 16, v214
    v_mul_f32 v214, v162, v162
    v_mul_f32 v214, 0x3d372713, v214
    v_add_f32 v214, 1.0, v214
    v_mul_f32 v214, v214, v162
    v_mul_f32 v214, 0x40135761, v214
    v_min_f32 v214, 0x42fc0000, v214
    v_exp_f32 v215, v214
    s_nop 1
    v_add_f32 v215, 1.0, v215
    v_rcp_f32 v215, v215
    s_nop 1
    v_fma_f32 v215, v215, -1.0, 1.0
    v_mul_f32 v162, v162, v215
    v_cvt_pk_bf16_f32 v214, v162, v162
    v_lshlrev_b32 v162, 16, v214
    v_mul_f32 v162, v162, v194
    v_cvt_pk_bf16_f32 v214, v163, v163
    v_lshlrev_b32 v163, 16, v214
    v_cvt_pk_bf16_f32 v214, v195, v195
    v_lshlrev_b32 v195, 16, v214
    v_mul_f32 v214, v163, v163
    v_mul_f32 v214, 0x3d372713, v214
    v_add_f32 v214, 1.0, v214
    v_mul_f32 v214, v214, v163
    v_mul_f32 v214, 0x40135761, v214
    v_min_f32 v214, 0x42fc0000, v214
    v_exp_f32 v215, v214
    s_nop 1
    v_add_f32 v215, 1.0, v215
    v_rcp_f32 v215, v215
    s_nop 1
    v_fma_f32 v215, v215, -1.0, 1.0
    v_mul_f32 v163, v163, v215
    v_cvt_pk_bf16_f32 v214, v163, v163
    v_lshlrev_b32 v163, 16, v214
    v_mul_f32 v163, v163, v195
    v_cvt_pk_bf16_f32 v220, v144, v145
    v_cvt_pk_bf16_f32 v221, v146, v147
    v_cvt_pk_bf16_f32 v222, v160, v161
    v_cvt_pk_bf16_f32 v223, v162, v163
    buffer_store_dwordx4 v[220:223], v208, s[12:15], s25 offen
    s_add_u32 s25, s25, 57344
    s_nop 1
    v_cvt_pk_bf16_f32 v214, v148, v148
    v_lshlrev_b32 v148, 16, v214
    v_cvt_pk_bf16_f32 v214, v180, v180
    v_lshlrev_b32 v180, 16, v214
    v_mul_f32 v214, v148, v148
    v_mul_f32 v214, 0x3d372713, v214
    v_add_f32 v214, 1.0, v214
    v_mul_f32 v214, v214, v148
    v_mul_f32 v214, 0x40135761, v214
    v_min_f32 v214, 0x42fc0000, v214
    v_exp_f32 v215, v214
    s_nop 1
    v_add_f32 v215, 1.0, v215
    v_rcp_f32 v215, v215
    s_nop 1
    v_fma_f32 v215, v215, -1.0, 1.0
    v_mul_f32 v148, v148, v215
    v_cvt_pk_bf16_f32 v214, v148, v148
    v_lshlrev_b32 v148, 16, v214
    v_mul_f32 v148, v148, v180
    v_cvt_pk_bf16_f32 v214, v149, v149
    v_lshlrev_b32 v149, 16, v214
    v_cvt_pk_bf16_f32 v214, v181, v181
    v_lshlrev_b32 v181, 16, v214
    v_mul_f32 v214, v149, v149
    v_mul_f32 v214, 0x3d372713, v214
    v_add_f32 v214, 1.0, v214
    v_mul_f32 v214, v214, v149
    v_mul_f32 v214, 0x40135761, v214
    v_min_f32 v214, 0x42fc0000, v214
    v_exp_f32 v215, v214
    s_nop 1
    v_add_f32 v215, 1.0, v215
    v_rcp_f32 v215, v215
    s_nop 1
    v_fma_f32 v215, v215, -1.0, 1.0
    v_mul_f32 v149, v149, v215
    v_cvt_pk_bf16_f32 v214, v149, v149
    v_lshlrev_b32 v149, 16, v214
    v_mul_f32 v149, v149, v181
    v_cvt_pk_bf16_f32 v214, v150, v150
    v_lshlrev_b32 v150, 16, v214
    v_cvt_pk_bf16_f32 v214, v182, v182
    v_lshlrev_b32 v182, 16, v214
    v_mul_f32 v214, v150, v150
    v_mul_f32 v214, 0x3d372713, v214
    v_add_f32 v214, 1.0, v214
    v_mul_f32 v214, v214, v150
    v_mul_f32 v214, 0x40135761, v214
    v_min_f32 v214, 0x42fc0000, v214
    v_exp_f32 v215, v214
    s_nop 1
    v_add_f32 v215, 1.0, v215
    v_rcp_f32 v215, v215
    s_nop 1
    v_fma_f32 v215, v215, -1.0, 1.0
    v_mul_f32 v150, v150, v215
    v_cvt_pk_bf16_f32 v214, v150, v150
    v_lshlrev_b32 v150, 16, v214
    v_mul_f32 v150, v150, v182
    v_cvt_pk_bf16_f32 v214, v151, v151
    v_lshlrev_b32 v151, 16, v214
    v_cvt_pk_bf16_f32 v214, v183, v183
    v_lshlrev_b32 v183, 16, v214
    v_mul_f32 v214, v151, v151
    v_mul_f32 v214, 0x3d372713, v214
    v_add_f32 v214, 1.0, v214
    v_mul_f32 v214, v214, v151
    v_mul_f32 v214, 0x40135761, v214
    v_min_f32 v214, 0x42fc0000, v214
    v_exp_f32 v215, v214
    s_nop 1
    v_add_f32 v215, 1.0, v215
    v_rcp_f32 v215, v215
    s_nop 1
    v_fma_f32 v215, v215, -1.0, 1.0
    v_mul_f32 v151, v151, v215
    v_cvt_pk_bf16_f32 v214, v151, v151
    v_lshlrev_b32 v151, 16, v214
    v_mul_f32 v151, v151, v183
    v_cvt_pk_bf16_f32 v214, v164, v164
    v_lshlrev_b32 v164, 16, v214
    v_cvt_pk_bf16_f32 v214, v196, v196
    v_lshlrev_b32 v196, 16, v214
    v_mul_f32 v214, v164, v164
    v_mul_f32 v214, 0x3d372713, v214
    v_add_f32 v214, 1.0, v214
    v_mul_f32 v214, v214, v164
    v_mul_f32 v214, 0x40135761, v214
    v_min_f32 v214, 0x42fc0000, v214
    v_exp_f32 v215, v214
    s_nop 1
    v_add_f32 v215, 1.0, v215
    v_rcp_f32 v215, v215
    s_nop 1
    v_fma_f32 v215, v215, -1.0, 1.0
    v_mul_f32 v164, v164, v215
    v_cvt_pk_bf16_f32 v214, v164, v164
    v_lshlrev_b32 v164, 16, v214
    v_mul_f32 v164, v164, v196
    v_cvt_pk_bf16_f32 v214, v165, v165
    v_lshlrev_b32 v165, 16, v214
    v_cvt_pk_bf16_f32 v214, v197, v197
    v_lshlrev_b32 v197, 16, v214
    v_mul_f32 v214, v165, v165
    v_mul_f32 v214, 0x3d372713, v214
    v_add_f32 v214, 1.0, v214
    v_mul_f32 v214, v214, v165
    v_mul_f32 v214, 0x40135761, v214
    v_min_f32 v214, 0x42fc0000, v214
    v_exp_f32 v215, v214
    s_nop 1
    v_add_f32 v215, 1.0, v215
    v_rcp_f32 v215, v215
    s_nop 1
    v_fma_f32 v215, v215, -1.0, 1.0
    v_mul_f32 v165, v165, v215
    v_cvt_pk_bf16_f32 v214, v165, v165
    v_lshlrev_b32 v165, 16, v214
    v_mul_f32 v165, v165, v197
    v_cvt_pk_bf16_f32 v214, v166, v166
    v_lshlrev_b32 v166, 16, v214
    v_cvt_pk_bf16_f32 v214, v198, v198
    v_lshlrev_b32 v198, 16, v214
    v_mul_f32 v214, v166, v166
    v_mul_f32 v214, 0x3d372713, v214
    v_add_f32 v214, 1.0, v214
    v_mul_f32 v214, v214, v166
    v_mul_f32 v214, 0x40135761, v214
    v_min_f32 v214, 0x42fc0000, v214
    v_exp_f32 v215, v214
    s_nop 1
    v_add_f32 v215, 1.0, v215
    v_rcp_f32 v215, v215
    s_nop 1
    v_fma_f32 v215, v215, -1.0, 1.0
    v_mul_f32 v166, v166, v215
    v_cvt_pk_bf16_f32 v214, v166, v166
    v_lshlrev_b32 v166, 16, v214
    v_mul_f32 v166, v166, v198
    v_cvt_pk_bf16_f32 v214, v167, v167
    v_lshlrev_b32 v167, 16, v214
    v_cvt_pk_bf16_f32 v214, v199, v199
    v_lshlrev_b32 v199, 16, v214
    v_mul_f32 v214, v167, v167
    v_mul_f32 v214, 0x3d372713, v214
    v_add_f32 v214, 1.0, v214
    v_mul_f32 v214, v214, v167
    v_mul_f32 v214, 0x40135761, v214
    v_min_f32 v214, 0x42fc0000, v214
    v_exp_f32 v215, v214
    s_nop 1
    v_add_f32 v215, 1.0, v215
    v_rcp_f32 v215, v215
    s_nop 1
    v_fma_f32 v215, v215, -1.0, 1.0
    v_mul_f32 v167, v167, v215
    v_cvt_pk_bf16_f32 v214, v167, v167
    v_lshlrev_b32 v167, 16, v214
    v_mul_f32 v167, v167, v199
    v_cvt_pk_bf16_f32 v220, v148, v149
    v_cvt_pk_bf16_f32 v221, v150, v151
    v_cvt_pk_bf16_f32 v222, v164, v165
    v_cvt_pk_bf16_f32 v223, v166, v167
    buffer_store_dwordx4 v[220:223], v208, s[12:15], s25 offen
    s_add_u32 s25, s25, 57344
    s_nop 1
    v_cvt_pk_bf16_f32 v214, v152, v152
    v_lshlrev_b32 v152, 16, v214
    v_cvt_pk_bf16_f32 v214, v184, v184
    v_lshlrev_b32 v184, 16, v214
    v_mul_f32 v214, v152, v152
    v_mul_f32 v214, 0x3d372713, v214
    v_add_f32 v214, 1.0, v214
    v_mul_f32 v214, v214, v152
    v_mul_f32 v214, 0x40135761, v214
    v_min_f32 v214, 0x42fc0000, v214
    v_exp_f32 v215, v214
    s_nop 1
    v_add_f32 v215, 1.0, v215
    v_rcp_f32 v215, v215
    s_nop 1
    v_fma_f32 v215, v215, -1.0, 1.0
    v_mul_f32 v152, v152, v215
    v_cvt_pk_bf16_f32 v214, v152, v152
    v_lshlrev_b32 v152, 16, v214
    v_mul_f32 v152, v152, v184
    v_cvt_pk_bf16_f32 v214, v153, v153
    v_lshlrev_b32 v153, 16, v214
    v_cvt_pk_bf16_f32 v214, v185, v185
    v_lshlrev_b32 v185, 16, v214
    v_mul_f32 v214, v153, v153
    v_mul_f32 v214, 0x3d372713, v214
    v_add_f32 v214, 1.0, v214
    v_mul_f32 v214, v214, v153
    v_mul_f32 v214, 0x40135761, v214
    v_min_f32 v214, 0x42fc0000, v214
    v_exp_f32 v215, v214
    s_nop 1
    v_add_f32 v215, 1.0, v215
    v_rcp_f32 v215, v215
    s_nop 1
    v_fma_f32 v215, v215, -1.0, 1.0
    v_mul_f32 v153, v153, v215
    v_cvt_pk_bf16_f32 v214, v153, v153
    v_lshlrev_b32 v153, 16, v214
    v_mul_f32 v153, v153, v185
    v_cvt_pk_bf16_f32 v214, v154, v154
    v_lshlrev_b32 v154, 16, v214
    v_cvt_pk_bf16_f32 v214, v186, v186
    v_lshlrev_b32 v186, 16, v214
    v_mul_f32 v214, v154, v154
    v_mul_f32 v214, 0x3d372713, v214
    v_add_f32 v214, 1.0, v214
    v_mul_f32 v214, v214, v154
    v_mul_f32 v214, 0x40135761, v214
    v_min_f32 v214, 0x42fc0000, v214
    v_exp_f32 v215, v214
    s_nop 1
    v_add_f32 v215, 1.0, v215
    v_rcp_f32 v215, v215
    s_nop 1
    v_fma_f32 v215, v215, -1.0, 1.0
    v_mul_f32 v154, v154, v215
    v_cvt_pk_bf16_f32 v214, v154, v154
    v_lshlrev_b32 v154, 16, v214
    v_mul_f32 v154, v154, v186
    v_cvt_pk_bf16_f32 v214, v155, v155
    v_lshlrev_b32 v155, 16, v214
    v_cvt_pk_bf16_f32 v214, v187, v187
    v_lshlrev_b32 v187, 16, v214
    v_mul_f32 v214, v155, v155
    v_mul_f32 v214, 0x3d372713, v214
    v_add_f32 v214, 1.0, v214
    v_mul_f32 v214, v214, v155
    v_mul_f32 v214, 0x40135761, v214
    v_min_f32 v214, 0x42fc0000, v214
    v_exp_f32 v215, v214
    s_nop 1
    v_add_f32 v215, 1.0, v215
    v_rcp_f32 v215, v215
    s_nop 1
    v_fma_f32 v215, v215, -1.0, 1.0
    v_mul_f32 v155, v155, v215
    v_cvt_pk_bf16_f32 v214, v155, v155
    v_lshlrev_b32 v155, 16, v214
    v_mul_f32 v155, v155, v187
    v_cvt_pk_bf16_f32 v214, v168, v168
    v_lshlrev_b32 v168, 16, v214
    v_cvt_pk_bf16_f32 v214, v200, v200
    v_lshlrev_b32 v200, 16, v214
    v_mul_f32 v214, v168, v168
    v_mul_f32 v214, 0x3d372713, v214
    v_add_f32 v214, 1.0, v214
    v_mul_f32 v214, v214, v168
    v_mul_f32 v214, 0x40135761, v214
    v_min_f32 v214, 0x42fc0000, v214
    v_exp_f32 v215, v214
    s_nop 1
    v_add_f32 v215, 1.0, v215
    v_rcp_f32 v215, v215
    s_nop 1
    v_fma_f32 v215, v215, -1.0, 1.0
    v_mul_f32 v168, v168, v215
    v_cvt_pk_bf16_f32 v214, v168, v168
    v_lshlrev_b32 v168, 16, v214
    v_mul_f32 v168, v168, v200
    v_cvt_pk_bf16_f32 v214, v169, v169
    v_lshlrev_b32 v169, 16, v214
    v_cvt_pk_bf16_f32 v214, v201, v201
    v_lshlrev_b32 v201, 16, v214
    v_mul_f32 v214, v169, v169
    v_mul_f32 v214, 0x3d372713, v214
    v_add_f32 v214, 1.0, v214
    v_mul_f32 v214, v214, v169
    v_mul_f32 v214, 0x40135761, v214
    v_min_f32 v214, 0x42fc0000, v214
    v_exp_f32 v215, v214
    s_nop 1
    v_add_f32 v215, 1.0, v215
    v_rcp_f32 v215, v215
    s_nop 1
    v_fma_f32 v215, v215, -1.0, 1.0
    v_mul_f32 v169, v169, v215
    v_cvt_pk_bf16_f32 v214, v169, v169
    v_lshlrev_b32 v169, 16, v214
    v_mul_f32 v169, v169, v201
    v_cvt_pk_bf16_f32 v214, v170, v170
    v_lshlrev_b32 v170, 16, v214
    v_cvt_pk_bf16_f32 v214, v202, v202
    v_lshlrev_b32 v202, 16, v214
    v_mul_f32 v214, v170, v170
    v_mul_f32 v214, 0x3d372713, v214
    v_add_f32 v214, 1.0, v214
    v_mul_f32 v214, v214, v170
    v_mul_f32 v214, 0x40135761, v214
    v_min_f32 v214, 0x42fc0000, v214
    v_exp_f32 v215, v214
    s_nop 1
    v_add_f32 v215, 1.0, v215
    v_rcp_f32 v215, v215
    s_nop 1
    v_fma_f32 v215, v215, -1.0, 1.0
    v_mul_f32 v170, v170, v215
    v_cvt_pk_bf16_f32 v214, v170, v170
    v_lshlrev_b32 v170, 16, v214
    v_mul_f32 v170, v170, v202
    v_cvt_pk_bf16_f32 v214, v171, v171
    v_lshlrev_b32 v171, 16, v214
    v_cvt_pk_bf16_f32 v214, v203, v203
    v_lshlrev_b32 v203, 16, v214
    v_mul_f32 v214, v171, v171
    v_mul_f32 v214, 0x3d372713, v214
    v_add_f32 v214, 1.0, v214
    v_mul_f32 v214, v214, v171
    v_mul_f32 v214, 0x40135761, v214
    v_min_f32 v214, 0x42fc0000, v214
    v_exp_f32 v215, v214
    s_nop 1
    v_add_f32 v215, 1.0, v215
    v_rcp_f32 v215, v215
    s_nop 1
    v_fma_f32 v215, v215, -1.0, 1.0
    v_mul_f32 v171, v171, v215
    v_cvt_pk_bf16_f32 v214, v171, v171
    v_lshlrev_b32 v171, 16, v214
    v_mul_f32 v171, v171, v203
    v_cvt_pk_bf16_f32 v220, v152, v153
    v_cvt_pk_bf16_f32 v221, v154, v155
    v_cvt_pk_bf16_f32 v222, v168, v169
    v_cvt_pk_bf16_f32 v223, v170, v171
    buffer_store_dwordx4 v[220:223], v208, s[12:15], s25 offen
    s_add_u32 s25, s25, 57344
    s_nop 1
    v_cvt_pk_bf16_f32 v214, v156, v156
    v_lshlrev_b32 v156, 16, v214
    v_cvt_pk_bf16_f32 v214, v188, v188
    v_lshlrev_b32 v188, 16, v214
    v_mul_f32 v214, v156, v156
    v_mul_f32 v214, 0x3d372713, v214
    v_add_f32 v214, 1.0, v214
    v_mul_f32 v214, v214, v156
    v_mul_f32 v214, 0x40135761, v214
    v_min_f32 v214, 0x42fc0000, v214
    v_exp_f32 v215, v214
    s_nop 1
    v_add_f32 v215, 1.0, v215
    v_rcp_f32 v215, v215
    s_nop 1
    v_fma_f32 v215, v215, -1.0, 1.0
    v_mul_f32 v156, v156, v215
    v_cvt_pk_bf16_f32 v214, v156, v156
    v_lshlrev_b32 v156, 16, v214
    v_mul_f32 v156, v156, v188
    v_cvt_pk_bf16_f32 v214, v157, v157
    v_lshlrev_b32 v157, 16, v214
    v_cvt_pk_bf16_f32 v214, v189, v189
    v_lshlrev_b32 v189, 16, v214
    v_mul_f32 v214, v157, v157
    v_mul_f32 v214, 0x3d372713, v214
    v_add_f32 v214, 1.0, v214
    v_mul_f32 v214, v214, v157
    v_mul_f32 v214, 0x40135761, v214
    v_min_f32 v214, 0x42fc0000, v214
    v_exp_f32 v215, v214
    s_nop 1
    v_add_f32 v215, 1.0, v215
    v_rcp_f32 v215, v215
    s_nop 1
    v_fma_f32 v215, v215, -1.0, 1.0
    v_mul_f32 v157, v157, v215
    v_cvt_pk_bf16_f32 v214, v157, v157
    v_lshlrev_b32 v157, 16, v214
    v_mul_f32 v157, v157, v189
    v_cvt_pk_bf16_f32 v214, v158, v158
    v_lshlrev_b32 v158, 16, v214
    v_cvt_pk_bf16_f32 v214, v190, v190
    v_lshlrev_b32 v190, 16, v214
    v_mul_f32 v214, v158, v158
    v_mul_f32 v214, 0x3d372713, v214
    v_add_f32 v214, 1.0, v214
    v_mul_f32 v214, v214, v158
    v_mul_f32 v214, 0x40135761, v214
    v_min_f32 v214, 0x42fc0000, v214
    v_exp_f32 v215, v214
    s_nop 1
    v_add_f32 v215, 1.0, v215
    v_rcp_f32 v215, v215
    s_nop 1
    v_fma_f32 v215, v215, -1.0, 1.0
    v_mul_f32 v158, v158, v215
    v_cvt_pk_bf16_f32 v214, v158, v158
    v_lshlrev_b32 v158, 16, v214
    v_mul_f32 v158, v158, v190
    v_cvt_pk_bf16_f32 v214, v159, v159
    v_lshlrev_b32 v159, 16, v214
    v_cvt_pk_bf16_f32 v214, v191, v191
    v_lshlrev_b32 v191, 16, v214
    v_mul_f32 v214, v159, v159
    v_mul_f32 v214, 0x3d372713, v214
    v_add_f32 v214, 1.0, v214
    v_mul_f32 v214, v214, v159
    v_mul_f32 v214, 0x40135761, v214
    v_min_f32 v214, 0x42fc0000, v214
    v_exp_f32 v215, v214
    s_nop 1
    v_add_f32 v215, 1.0, v215
    v_rcp_f32 v215, v215
    s_nop 1
    v_fma_f32 v215, v215, -1.0, 1.0
    v_mul_f32 v159, v159, v215
    v_cvt_pk_bf16_f32 v214, v159, v159
    v_lshlrev_b32 v159, 16, v214
    v_mul_f32 v159, v159, v191
    v_cvt_pk_bf16_f32 v214, v172, v172
    v_lshlrev_b32 v172, 16, v214
    v_cvt_pk_bf16_f32 v214, v204, v204
    v_lshlrev_b32 v204, 16, v214
    v_mul_f32 v214, v172, v172
    v_mul_f32 v214, 0x3d372713, v214
    v_add_f32 v214, 1.0, v214
    v_mul_f32 v214, v214, v172
    v_mul_f32 v214, 0x40135761, v214
    v_min_f32 v214, 0x42fc0000, v214
    v_exp_f32 v215, v214
    s_nop 1
    v_add_f32 v215, 1.0, v215
    v_rcp_f32 v215, v215
    s_nop 1
    v_fma_f32 v215, v215, -1.0, 1.0
    v_mul_f32 v172, v172, v215
    v_cvt_pk_bf16_f32 v214, v172, v172
    v_lshlrev_b32 v172, 16, v214
    v_mul_f32 v172, v172, v204
    v_cvt_pk_bf16_f32 v214, v173, v173
    v_lshlrev_b32 v173, 16, v214
    v_cvt_pk_bf16_f32 v214, v205, v205
    v_lshlrev_b32 v205, 16, v214
    v_mul_f32 v214, v173, v173
    v_mul_f32 v214, 0x3d372713, v214
    v_add_f32 v214, 1.0, v214
    v_mul_f32 v214, v214, v173
    v_mul_f32 v214, 0x40135761, v214
    v_min_f32 v214, 0x42fc0000, v214
    v_exp_f32 v215, v214
    s_nop 1
    v_add_f32 v215, 1.0, v215
    v_rcp_f32 v215, v215
    s_nop 1
    v_fma_f32 v215, v215, -1.0, 1.0
    v_mul_f32 v173, v173, v215
    v_cvt_pk_bf16_f32 v214, v173, v173
    v_lshlrev_b32 v173, 16, v214
    v_mul_f32 v173, v173, v205
    v_cvt_pk_bf16_f32 v214, v174, v174
    v_lshlrev_b32 v174, 16, v214
    v_cvt_pk_bf16_f32 v214, v206, v206
    v_lshlrev_b32 v206, 16, v214
    v_mul_f32 v214, v174, v174
    v_mul_f32 v214, 0x3d372713, v214
    v_add_f32 v214, 1.0, v214
    v_mul_f32 v214, v214, v174
    v_mul_f32 v214, 0x40135761, v214
    v_min_f32 v214, 0x42fc0000, v214
    v_exp_f32 v215, v214
    s_nop 1
    v_add_f32 v215, 1.0, v215
    v_rcp_f32 v215, v215
    s_nop 1
    v_fma_f32 v215, v215, -1.0, 1.0
    v_mul_f32 v174, v174, v215
    v_cvt_pk_bf16_f32 v214, v174, v174
    v_lshlrev_b32 v174, 16, v214
    v_mul_f32 v174, v174, v206
    v_cvt_pk_bf16_f32 v214, v175, v175
    v_lshlrev_b32 v175, 16, v214
    v_cvt_pk_bf16_f32 v214, v207, v207
    v_lshlrev_b32 v207, 16, v214
    v_mul_f32 v214, v175, v175
    v_mul_f32 v214, 0x3d372713, v214
    v_add_f32 v214, 1.0, v214
    v_mul_f32 v214, v214, v175
    v_mul_f32 v214, 0x40135761, v214
    v_min_f32 v214, 0x42fc0000, v214
    v_exp_f32 v215, v214
    s_nop 1
    v_add_f32 v215, 1.0, v215
    v_rcp_f32 v215, v215
    s_nop 1
    v_fma_f32 v215, v215, -1.0, 1.0
    v_mul_f32 v175, v175, v215
    v_cvt_pk_bf16_f32 v214, v175, v175
    v_lshlrev_b32 v175, 16, v214
    v_mul_f32 v175, v175, v207
    v_cvt_pk_bf16_f32 v220, v156, v157
    v_cvt_pk_bf16_f32 v221, v158, v159
    v_cvt_pk_bf16_f32 v222, v172, v173
    v_cvt_pk_bf16_f32 v223, v174, v175
    buffer_store_dwordx4 v[220:223], v208, s[12:15], s25 offen
    s_add_u32 s25, s25, 57344
    s_nop 1
gu_kernel_end:
    s_endpgm
.globl dn_kernel
.p2align 8
.type dn_kernel,@function
dn_kernel:
    s_load_dwordx2 s[38:39], s[0:1], 104
    s_load_dwordx2 s[36:37], s[0:1], 88
    s_cmp_ge_u32 s2, 256
    s_cbranch_scc1 dn_kernel_end
    v_and_b32 v1, 63, v0
    v_lshrrev_b32 v2, 4, v1
    v_and_b32 v3, 15, v1
    v_lshrrev_b32 v4, 6, v0
    s_nop 0
    v_readfirstlane_b32 s3, v4
    s_waitcnt lgkmcnt(0)
    s_mov_b32 s12, s38
    s_mov_b32 s13, s39
    s_mov_b32 s14, 0x10000000
    s_mov_b32 s15, 0x20000
    s_lshr_b32 s4, s3, 1
    s_and_b32 s5, s3, 1
    s_and_b32 s8, s2, 31
    s_lshr_b32 s9, s2, 5
    s_mul_i32 s20, s9, 229376
    s_add_u32 s20, s20, 0x1580000
    s_mul_i32 s22, s8, 229376
    s_add_u32 s22, s22, 0x7400000
    s_mov_b32 s21, 57344
    s_mov_b32 s23, 57344
    s_lshl_b32 s25, s8, 16
    s_lshl_b32 s16, s9, 7
    s_add_u32 s25, s25, s16
    s_mov_b32 s16, s36
    s_mov_b32 s17, s37
    s_mov_b32 s18, 0x200000
    s_mov_b32 s19, 0x20000
    v_lshlrev_b32 v4, 4, v1
    s_mul_i32 s6, s4, 2
    s_mul_i32 s6, s6, s21
    s_add_u32 s6, s6, s20
    s_mul_i32 s7, s5, 2
    s_mul_i32 s7, s7, s23
    s_add_u32 s7, s7, s22
    v_add_u32 v8, s6, v4
    s_add_u32 s6, s6, s21
    v_add_u32 v9, s6, v4
    s_add_u32 s6, s6, s21
    v_add_u32 v12, s7, v4
    s_add_u32 s7, s7, s23
    v_add_u32 v13, s7, v4
    s_add_u32 s7, s7, s23
    v_mov_b32 v144, 0
    v_mov_b32 v145, 0
    v_mov_b32 v146, 0
    v_mov_b32 v147, 0
    v_mov_b32 v148, 0
    v_mov_b32 v149, 0
    v_mov_b32 v150, 0
    v_mov_b32 v151, 0
    v_mov_b32 v152, 0
    v_mov_b32 v153, 0
    v_mov_b32 v154, 0
    v_mov_b32 v155, 0
    v_mov_b32 v156, 0
    v_mov_b32 v157, 0
    v_mov_b32 v158, 0
    v_mov_b32 v159, 0
    v_mov_b32 v160, 0
    v_mov_b32 v161, 0
    v_mov_b32 v162, 0
    v_mov_b32 v163, 0
    v_mov_b32 v164, 0
    v_mov_b32 v165, 0
    v_mov_b32 v166, 0
    v_mov_b32 v167, 0
    v_mov_b32 v168, 0
    v_mov_b32 v169, 0
    v_mov_b32 v170, 0
    v_mov_b32 v171, 0
    v_mov_b32 v172, 0
    v_mov_b32 v173, 0
    v_mov_b32 v174, 0
    v_mov_b32 v175, 0
    v_mov_b32 v176, 0
    v_mov_b32 v177, 0
    v_mov_b32 v178, 0
    v_mov_b32 v179, 0
    v_mov_b32 v180, 0
    v_mov_b32 v181, 0
    v_mov_b32 v182, 0
    v_mov_b32 v183, 0
    v_mov_b32 v184, 0
    v_mov_b32 v185, 0
    v_mov_b32 v186, 0
    v_mov_b32 v187, 0
    v_mov_b32 v188, 0
    v_mov_b32 v189, 0
    v_mov_b32 v190, 0
    v_mov_b32 v191, 0
    v_mov_b32 v192, 0
    v_mov_b32 v193, 0
    v_mov_b32 v194, 0
    v_mov_b32 v195, 0
    v_mov_b32 v196, 0
    v_mov_b32 v197, 0
    v_mov_b32 v198, 0
    v_mov_b32 v199, 0
    v_mov_b32 v200, 0
    v_mov_b32 v201, 0
    v_mov_b32 v202, 0
    v_mov_b32 v203, 0
    v_mov_b32 v204, 0
    v_mov_b32 v205, 0
    v_mov_b32 v206, 0
    v_mov_b32 v207, 0
    s_mov_b32 s24, 0
    buffer_load_dwordx4 v[16:19], v8, s[12:15], s24 offen
    buffer_load_dwordx4 v[20:23], v9, s[12:15], s24 offen
    buffer_load_dwordx4 v[32:35], v12, s[12:15], s24 offen
    buffer_load_dwordx4 v[36:39], v13, s[12:15], s24 offen
    buffer_load_dwordx4 v[48:51], v8, s[12:15], s24 offen offset:1024
    buffer_load_dwordx4 v[52:55], v9, s[12:15], s24 offen offset:1024
    buffer_load_dwordx4 v[64:67], v12, s[12:15], s24 offen offset:1024
    buffer_load_dwordx4 v[68:71], v13, s[12:15], s24 offen offset:1024
    buffer_load_dwordx4 v[80:83], v8, s[12:15], s24 offen offset:2048
    buffer_load_dwordx4 v[84:87], v9, s[12:15], s24 offen offset:2048
    buffer_load_dwordx4 v[96:99], v12, s[12:15], s24 offen offset:2048
    buffer_load_dwordx4 v[100:103], v13, s[12:15], s24 offen offset:2048
dn_kernel_loop:
    buffer_load_dwordx4 v[112:115], v8, s[12:15], s24 offen offset:3072
    buffer_load_dwordx4 v[116:119], v9, s[12:15], s24 offen offset:3072
    buffer_load_dwordx4 v[128:131], v12, s[12:15], s24 offen offset:3072
    buffer_load_dwordx4 v[132:135], v13, s[12:15], s24 offen offset:3072
    s_add_u32 s24, s24, 4096
    s_waitcnt vmcnt(12)
    v_mfma_f32_16x16x32_bf16 v[144:147], v[16:19], v[32:35], v[144:147]
    v_mfma_f32_16x16x32_bf16 v[148:151], v[16:19], v[36:39], v[148:151]
    v_mfma_f32_16x16x32_bf16 v[160:163], v[20:23], v[32:35], v[160:163]
    v_mfma_f32_16x16x32_bf16 v[164:167], v[20:23], v[36:39], v[164:167]
    buffer_load_dwordx4 v[16:19], v8, s[12:15], s24 offen
    buffer_load_dwordx4 v[20:23], v9, s[12:15], s24 offen
    buffer_load_dwordx4 v[32:35], v12, s[12:15], s24 offen
    buffer_load_dwordx4 v[36:39], v13, s[12:15], s24 offen
    s_waitcnt vmcnt(12)
    v_mfma_f32_16x16x32_bf16 v[144:147], v[48:51], v[64:67], v[144:147]
    v_mfma_f32_16x16x32_bf16 v[148:151], v[48:51], v[68:71], v[148:151]
    v_mfma_f32_16x16x32_bf16 v[160:163], v[52:55], v[64:67], v[160:163]
    v_mfma_f32_16x16x32_bf16 v[164:167], v[52:55], v[68:71], v[164:167]
    buffer_load_dwordx4 v[48:51], v8, s[12:15], s24 offen offset:1024
    buffer_load_dwordx4 v[52:55], v9, s[12:15], s24 offen offset:1024
    buffer_load_dwordx4 v[64:67], v12, s[12:15], s24 offen offset:1024
    buffer_load_dwordx4 v[68:71], v13, s[12:15], s24 offen offset:1024
    s_waitcnt vmcnt(12)
    v_mfma_f32_16x16x32_bf16 v[144:147], v[80:83], v[96:99], v[144:147]
    v_mfma_f32_16x16x32_bf16 v[148:151], v[80:83], v[100:103], v[148:151]
    v_mfma_f32_16x16x32_bf16 v[160:163], v[84:87], v[96:99], v[160:163]
    v_mfma_f32_16x16x32_bf16 v[164:167], v[84:87], v[100:103], v[164:167]
    buffer_load_dwordx4 v[80:83], v8, s[12:15], s24 offen offset:2048
    buffer_load_dwordx4 v[84:87], v9, s[12:15], s24 offen offset:2048
    buffer_load_dwordx4 v[96:99], v12, s[12:15], s24 offen offset:2048
    buffer_load_dwordx4 v[100:103], v13, s[12:15], s24 offen offset:2048
    s_waitcnt vmcnt(12)
    v_mfma_f32_16x16x32_bf16 v[144:147], v[112:115], v[128:131], v[144:147]
    v_mfma_f32_16x16x32_bf16 v[148:151], v[112:115], v[132:135], v[148:151]
    v_mfma_f32_16x16x32_bf16 v[160:163], v[116:119], v[128:131], v[160:163]
    v_mfma_f32_16x16x32_bf16 v[164:167], v[116:119], v[132:135], v[164:167]
    s_cmp_lt_u32 s24, 57344
    s_cbranch_scc1 dn_kernel_loop
    s_waitcnt vmcnt(0)
    s_nop 7
    s_nop 7
    s_lshl_b32 s6, s5, 5
    v_add_u32 v208, s6, v3
    v_lshlrev_b32 v208, 10, v208
    s_lshl_b32 s6, s4, 5
    v_lshl_add_u32 v209, v2, 2, s6
    v_lshl_add_u32 v208, v209, 1, v208
    s_add_u32 s26, s25, 0x7000000
    buffer_load_dwordx2 v[210:211], v208, s[12:15], s26 offen offset:0
    buffer_load_dwordx2 v[212:213], v208, s[12:15], s26 offen offset:32
    s_waitcnt vmcnt(0)
    v_cvt_pk_bf16_f32 v224, v144, v144
    v_lshlrev_b32 v144, 16, v224
    v_lshlrev_b32 v225, 16, v210
    v_add_f32 v144, v144, v225
    v_cvt_pk_bf16_f32 v224, v145, v145
    v_lshlrev_b32 v145, 16, v224
    v_and_b32 v225, 0xffff0000, v210
    v_add_f32 v145, v145, v225
    v_cvt_pk_bf16_f32 v224, v146, v146
    v_lshlrev_b32 v146, 16, v224
    v_lshlrev_b32 v225, 16, v211
    v_add_f32 v146, v146, v225
    v_cvt_pk_bf16_f32 v224, v147, v147
    v_lshlrev_b32 v147, 16, v224
    v_and_b32 v225, 0xffff0000, v211
    v_add_f32 v147, v147, v225
    v_cvt_pk_bf16_f32 v210, v144, v145
    v_cvt_pk_bf16_f32 v211, v146, v147
    v_cvt_pk_bf16_f32 v224, v160, v160
    v_lshlrev_b32 v160, 16, v224
    v_lshlrev_b32 v225, 16, v212
    v_add_f32 v160, v160, v225
    v_cvt_pk_bf16_f32 v224, v161, v161
    v_lshlrev_b32 v161, 16, v224
    v_and_b32 v225, 0xffff0000, v212
    v_add_f32 v161, v161, v225
    v_cvt_pk_bf16_f32 v224, v162, v162
    v_lshlrev_b32 v162, 16, v224
    v_lshlrev_b32 v225, 16, v213
    v_add_f32 v162, v162, v225
    v_cvt_pk_bf16_f32 v224, v163, v163
    v_lshlrev_b32 v163, 16, v224
    v_and_b32 v225, 0xffff0000, v213
    v_add_f32 v163, v163, v225
    v_cvt_pk_bf16_f32 v212, v160, v161
    v_cvt_pk_bf16_f32 v213, v162, v163
    buffer_store_dwordx2 v[210:211], v208, s[16:19], s25 offen offset:0
    buffer_store_dwordx2 v[212:213], v208, s[16:19], s25 offen offset:32
    s_add_u32 s25, s25, 16384
    s_add_u32 s26, s26, 16384
    s_waitcnt vmcnt(0)
    buffer_load_dwordx2 v[210:211], v208, s[12:15], s26 offen offset:0
    buffer_load_dwordx2 v[212:213], v208, s[12:15], s26 offen offset:32
    s_waitcnt vmcnt(0)
    v_cvt_pk_bf16_f32 v224, v148, v148
    v_lshlrev_b32 v148, 16, v224
    v_lshlrev_b32 v225, 16, v210
    v_add_f32 v148, v148, v225
    v_cvt_pk_bf16_f32 v224, v149, v149
    v_lshlrev_b32 v149, 16, v224
    v_and_b32 v225, 0xffff0000, v210
    v_add_f32 v149, v149, v225
    v_cvt_pk_bf16_f32 v224, v150, v150
    v_lshlrev_b32 v150, 16, v224
    v_lshlrev_b32 v225, 16, v211
    v_add_f32 v150, v150, v225
    v_cvt_pk_bf16_f32 v224, v151, v151
    v_lshlrev_b32 v151, 16, v224
    v_and_b32 v225, 0xffff0000, v211
    v_add_f32 v151, v151, v225
    v_cvt_pk_bf16_f32 v210, v148, v149
    v_cvt_pk_bf16_f32 v211, v150, v151
    v_cvt_pk_bf16_f32 v224, v164, v164
    v_lshlrev_b32 v164, 16, v224
    v_lshlrev_b32 v225, 16, v212
    v_add_f32 v164, v164, v225
    v_cvt_pk_bf16_f32 v224, v165, v165
    v_lshlrev_b32 v165, 16, v224
    v_and_b32 v225, 0xffff0000, v212
    v_add_f32 v165, v165, v225
    v_cvt_pk_bf16_f32 v224, v166, v166
    v_lshlrev_b32 v166, 16, v224
    v_lshlrev_b32 v225, 16, v213
    v_add_f32 v166, v166, v225
    v_cvt_pk_bf16_f32 v224, v167, v167
    v_lshlrev_b32 v167, 16, v224
    v_and_b32 v225, 0xffff0000, v213
    v_add_f32 v167, v167, v225
    v_cvt_pk_bf16_f32 v212, v164, v165
    v_cvt_pk_bf16_f32 v213, v166, v167
    buffer_store_dwordx2 v[210:211], v208, s[16:19], s25 offen offset:0
    buffer_store_dwordx2 v[212:213], v208, s[16:19], s25 offen offset:32
    s_add_u32 s25, s25, 16384
    s_add_u32 s26, s26, 16384
    s_waitcnt vmcnt(0)
dn_kernel_end:
    s_endpgm
.section .rodata,"a"
.p2align 6
.amdhsa_kernel prep_kernel
  .amdhsa_next_free_vgpr 64
  .amdhsa_next_free_sgpr 64
  .amdhsa_accum_offset 64
  .amdhsa_group_segment_fixed_size 0
  .amdhsa_kernarg_size 112
  .amdhsa_user_sgpr_count 2
  .amdhsa_user_sgpr_kernarg_segment_ptr 1
  .amdhsa_system_sgpr_workgroup_id_x 1
.end_amdhsa_kernel
.p2align 6
.amdhsa_kernel rec_kernel
  .amdhsa_next_free_vgpr 512
  .amdhsa_next_free_sgpr 96
  .amdhsa_accum_offset 256
  .amdhsa_group_segment_fixed_size 0
  .amdhsa_kernarg_size 112
  .amdhsa_user_sgpr_count 2
  .amdhsa_user_sgpr_kernarg_segment_ptr 1
  .amdhsa_system_sgpr_workgroup_id_x 1
.end_amdhsa_kernel
.p2align 6
.amdhsa_kernel attn_kernel
  .amdhsa_next_free_vgpr 220
  .amdhsa_next_free_sgpr 64
  .amdhsa_accum_offset 220
  .amdhsa_group_segment_fixed_size 0
  .amdhsa_kernarg_size 112
  .amdhsa_user_sgpr_count 2
  .amdhsa_user_sgpr_kernarg_segment_ptr 1
  .amdhsa_system_sgpr_workgroup_id_x 1
.end_amdhsa_kernel
.p2align 6
.amdhsa_kernel wo_kernel
  .amdhsa_next_free_vgpr 232
  .amdhsa_next_free_sgpr 64
  .amdhsa_accum_offset 232
  .amdhsa_group_segment_fixed_size 0
  .amdhsa_kernarg_size 112
  .amdhsa_user_sgpr_count 2
  .amdhsa_user_sgpr_kernarg_segment_ptr 1
  .amdhsa_system_sgpr_workgroup_id_x 1
.end_amdhsa_kernel
.p2align 6
.amdhsa_kernel ln2_kernel
  .amdhsa_next_free_vgpr 64
  .amdhsa_next_free_sgpr 64
  .amdhsa_accum_offset 64
  .amdhsa_group_segment_fixed_size 0
  .amdhsa_kernarg_size 112
  .amdhsa_user_sgpr_count 2
  .amdhsa_user_sgpr_kernarg_segment_ptr 1
  .amdhsa_system_sgpr_workgroup_id_x 1
.end_amdhsa_kernel
.p2align 6
.amdhsa_kernel gu_kernel
  .amdhsa_next_free_vgpr 232
  .amdhsa_next_free_sgpr 64
  .amdhsa_accum_offset 232
  .amdhsa_group_segment_fixed_size 0
  .amdhsa_kernarg_size 112
  .amdhsa_user_sgpr_count 2
  .amdhsa_user_sgpr_kernarg_segment_ptr 1
  .amdhsa_system_sgpr_workgroup_id_x 1
.end_amdhsa_kernel
.p2align 6
.amdhsa_kernel dn_kernel
  .amdhsa_next_free_vgpr 232
  .amdhsa_next_free_sgpr 64
  .amdhsa_accum_offset 232
  .amdhsa_group_segment_fixed_size 0
  .amdhsa_kernarg_size 112
  .amdhsa_user_sgpr_count 2
  .amdhsa_user_sgpr_kernarg_segment_ptr 1
  .amdhsa_system_sgpr_workgroup_id_x 1
.end_amdhsa_kernel
```
